```python
import torch

def _softmax(x, axis=-1):
    return torch.softmax(x, dim=axis)

def _gelu(x):
    return torch.nn.functional.gelu(x, approximate='tanh')

def _silu(x):
    return torch.nn.functional.silu(x)

def _sigmoid(x):
    return torch.sigmoid(x)

def _layernorm(x, axis=-1, eps=1e-05):
    m = x.mean(dim=axis, keepdim=True)
    v = x.var(dim=axis, keepdim=True, unbiased=False)
    return (x - m) / torch.sqrt(v + eps)

def _scatter_add(tgt, idx, src, axis=0):
    return tgt.clone().index_add_(axis, idx, src)

def _segment_sum(src, seg, n):
    out = torch.zeros((n,) + src.shape[1:], dtype=src.dtype)
    return out.index_add_(0, seg, src)

def _pad(x, pw):
    flat = tuple((v for pair in reversed(pw) for v in pair))
    return torch.nn.functional.pad(x, flat)
kernel_name = 'adaLN_cond__gqa_block_cached__dense_activation_squared_relu__decode'

def setup_inputs():

    _w = lambda a: (lambda t: t.to(torch.bfloat16) if t.is_floating_point() else t)(torch.as_tensor(a))

    def _A_setup():
        B, Sq, D = (2, 1, 576)
        Hq, Hkv, Sk, Dh = (32, 16, 8192, 128)
        assert Hq % Hkv == 0, (Hq, Hkv)
        return {'x': _w((lambda *s: torch.randn(*s, dtype=torch.bfloat16) * 0.05)(B, Sq, D)), 'k_cache': _w((lambda *s: torch.randn(*s, dtype=torch.bfloat16) * 3.2)(B, Hkv, Sk, Dh)), 'v_cache': _w((lambda *s: torch.randn(*s, dtype=torch.bfloat16) * 0.4)(B, Hkv, Sk, Dh)), 'wq': _w((lambda *s: torch.randn(*s, dtype=torch.bfloat16) * 3.2)(D, Hq * Dh) * D ** (-0.5)), 'wo': _w((lambda *s: torch.randn(*s, dtype=torch.bfloat16) * 0.4)(Hq * Dh, D) * (Hq * Dh) ** (-0.5))}
    _A_in = _A_setup()

    def _B_setup():
        B, S, D, F = (2, 1, 576, 4608)
        return {'x': _w((lambda *s: torch.randn(*s, dtype=torch.bfloat16) * 0.05)(B, S, D)), 'w1': _w((lambda *s: torch.randn(*s, dtype=torch.bfloat16) * 0.05)(D, F)), 'b1': _w((lambda *s: torch.randn(*s, dtype=torch.bfloat16) * 0.4)(F)), 'w2': _w((lambda *s: torch.randn(*s, dtype=torch.bfloat16) * 0.05)(F, D)), 'b2': _w((lambda *s: torch.randn(*s, dtype=torch.bfloat16) * 3.2)(D))}
    _B_in = _B_setup()
    return {'A_x': _A_in['x'], 'A_k_cache': _A_in['k_cache'], 'A_v_cache': _A_in['v_cache'], 'A_wq': _A_in['wq'], 'A_wo': _A_in['wo'], 'B_x': _B_in['x'], 'B_w1': _B_in['w1'], 'B_b1': _B_in['b1'], 'B_w2': _B_in['w2'], 'B_b2': _B_in['b2'], 'c': _w((lambda *s: torch.randn(*s, dtype=torch.bfloat16) * 0.1)(2, 576) * 8.0), 'w_mod': _w((lambda *s: torch.randn(*s, dtype=torch.bfloat16) * 0.1)(576, 6 * 576) * 576 ** (-0.5) * 8.0)}

def reference(A_x, A_k_cache, A_v_cache, A_wq, A_wo, B_x, B_w1, B_b1, B_w2, B_b2, c, w_mod):

    def _A_ref(x, k_cache, v_cache, wq, wo):
        B, Sq, D = x.shape
        Hq, Dh = (32, 128)
        Hkv = k_cache.shape[1]
        rep = Hq // Hkv
        q = (lambda x, *d: x.permute(*d))((x @ wq).reshape(B, Sq, Hq, Dh), 0, 2, 1, 3)
        k = (lambda x, n, axis: torch.repeat_interleave(x, n, dim=axis))(k_cache, rep, axis=1)
        v = (lambda x, n, axis: torch.repeat_interleave(x, n, dim=axis))(v_cache, rep, axis=1)
        scores = torch.einsum('bhqd,bhkd->bhqk', q, k) * Dh ** (-0.5)
        p = _softmax(scores, axis=-1)
        o = torch.einsum('bhqk,bhkd->bhqd', p, v)
        return (lambda x, *d: x.permute(*d))(o, 0, 2, 1, 3).reshape(B, Sq, Hq * Dh) @ wo

    def _B_ref(x, w1, b1, w2, b2):
        h = torch.einsum('bsd,df->bsf', x, w1) + b1
        zero = torch.zeros_like(h)
        r = torch.where(h > zero, h, zero)
        h = r * r
        out = torch.einsum('bsf,fd->bsd', h, w2) + b2
        return out
    x = A_x
    mod = (_silu(c) @ w_mod).reshape(c.shape[0], 6, 1, -1)
    sa, ca, ga, sb, cb, gb = (mod[:, 0].clone(), mod[:, 1].clone(), mod[:, 2].clone(), mod[:, 3].clone(), mod[:, 4].clone(), mod[:, 5].clone())
    h = _layernorm(x, axis=-1) * (1 + ca) + sa
    x = x + ga * _A_ref(h, A_k_cache, A_v_cache, A_wq, A_wo)
    h = _layernorm(x, axis=-1) * (1 + cb) + sb
    x = x + gb * _B_ref(h, B_w1, B_b1, B_w2, B_b2)
    return x
```

```asm
; @launch grid=(256,1,1) block=(512,1,1) lds=156288
.amdgcn_target "amdgcn-amd-amdhsa--gfx950"
.text
.globl adaLN_cond__gqa_block_cached__dense_activation_squared_relu__decode_kernel
.p2align 8
.type adaLN_cond__gqa_block_cached__dense_activation_squared_relu__decode_kernel,@function
adaLN_cond__gqa_block_cached__dense_activation_squared_relu__decode_kernel:
s_cmp_ge_u32 s2, 256
s_cbranch_scc1 L_end
s_load_dwordx2 s[8:9], s[0:1], 8
s_load_dwordx16 s[32:47], s[0:1], 0
v_lshrrev_b32 v2, 6, v0
s_load_dwordx8 s[48:55], s[0:1], 64
s_load_dwordx4 s[56:59], s[0:1], 96
s_load_dwordx2 s[60:61], s[0:1], 112
v_readfirstlane_b32 s62, v2
v_and_b32 v1, 63, v0
s_lshr_b32 s63, s2, 3
s_and_b32 s64, s2, 7
s_cbranch_scc0 L_tail
v_lshrrev_b32 v6, 4, v1
v_bfe_u32 v7, v1, 2, 2
v_and_b32 v8, 3, v1
s_lshl_b32 s16, s64, 3
s_lshl_b32 s17, s63, 21
s_mov_b32 s10, 0x4000000
s_mov_b32 s11, 0x20000
v_lshlrev_b32 v6, 6, v6
v_lshlrev_b32 v7, 8, v7
v_lshlrev_b32 v8, 4, v8
s_add_u32 s16, s16, s62
s_sub_u32 s16, s16, 8
s_mul_i32 s16, s16, 26624
s_add_u32 s16, s16, s17
v_add3_u32 v2, v6, v7, v8
s_waitcnt lgkmcnt(0)
buffer_load_dwordx4 v[16:19], v2, s[8:11], s16 offen offset:0 nt
buffer_load_dwordx4 v[20:23], v2, s[8:11], s16 offen offset:1024 nt
s_mul_i32 s24, s63, 37
s_lshr_b32 s24, s24, 8
s_mul_i32 s24, s24, 7
s_sub_u32 s24, s63, s24
s_add_u32 s64, s64, 6
s_sub_u32 s64, s64, s24
s_cmp_gt_u32 s64, 6
s_cselect_b32 s18, 7, 0
s_sub_u32 s64, s64, s18
s_cmp_ge_u32 s63, 22
s_cselect_b32 s26, 15, 3
s_add_u32 s75, s63, 22
s_cmp_eq_u32 s64, 0
s_cselect_b32 s72, 3981312, 0
s_cmp_eq_u32 s64, s26
s_cselect_b32 s72, 3981312, s72
s_cselect_b32 s75, s63, s75
s_cmp_eq_u32 s72, 0
s_cbranch_scc1 L_s_noGd
s_mov_b32 s28, s52
s_mov_b32 s29, s53
s_mov_b32 s30, 2304
s_mov_b32 s31, 0x20000
v_lshlrev_b32 v241, 2, v0
v_cmp_gt_u32 vcc, 288, v0
v_mov_b32 v6, 2147483648
s_nop 0
v_cndmask_b32 v241, v6, v241, vcc
s_mov_b64 s[76:77], vcc
buffer_load_dword v244, v241, s[28:31], 0 offen
buffer_load_dword v245, v241, s[28:31], 0 offen offset:1152
v_lshrrev_b32 v6, 3, v1
v_bfe_u32 v240, v1, 1, 2
v_lshrrev_b32 v7, 4, v1
v_sub_u32 v240, v240, v7
v_and_b32 v240, 3, v240
v_lshlrev_b32 v240, 5, v240
v_and_b32 v7, 1, v1
v_lshl_add_u32 v240, v7, 4, v240
v_mul_u32_u24 v6, 6912, v6
v_add_u32 v240, v240, v6
s_lshl_b32 s73, s75, 7
s_mul_i32 s74, s62, 55296
s_add_u32 s73, s73, s74
s_lshl_b32 s74, s62, 10
s_mov_b32 s28, s54
s_mov_b32 s29, s55
s_mov_b32 s30, 3981312
s_mov_b32 s31, 0x20000
s_add_u32 m0, s74, 16384
s_add_u32 s17, s73, 0
buffer_load_dwordx4 v240, s[28:31], s17 offen nt lds
s_add_u32 m0, s74, 24576
s_add_u32 s17, s73, 442368
buffer_load_dwordx4 v240, s[28:31], s17 offen nt lds
s_add_u32 m0, s74, 32768
s_add_u32 s17, s73, 884736
buffer_load_dwordx4 v240, s[28:31], s17 offen nt lds
s_add_u32 m0, s74, 40960
s_add_u32 s17, s73, 1327104
buffer_load_dwordx4 v240, s[28:31], s17 offen nt lds
s_add_u32 m0, s74, 49152
s_add_u32 s17, s73, 1769472
buffer_load_dwordx4 v240, s[28:31], s17 offen nt lds
s_add_u32 m0, s74, 57344
s_add_u32 s17, s73, 2211840
buffer_load_dwordx4 v240, s[28:31], s17 offen nt lds
s_add_u32 m0, s74, 65536
s_add_u32 s17, s73, 2654208
buffer_load_dwordx4 v240, s[28:31], s17 offen nt lds
s_add_u32 m0, s74, 73728
s_add_u32 s17, s73, 3096576
buffer_load_dwordx4 v240, s[28:31], s17 offen nt lds
s_add_u32 m0, s74, 81920
s_add_u32 s17, s73, 3538944
buffer_load_dwordx4 v240, s[28:31], s17 offen nt lds
L_s_noGd:
s_cmp_lg_u32 s62, 7
s_cbranch_scc1 L_1
s_getpc_b64 s[4:5]
L_pc_2:
s_sub_u32 s4, s4, L_pc_2-adaLN_cond__gqa_block_cached__dense_activation_squared_relu__decode_kernel
s_subb_u32 s5, s5, 0
s_mov_b32 s6, L_code_end-adaLN_cond__gqa_block_cached__dense_activation_squared_relu__decode_kernel
s_mov_b32 s7, 0x20000
s_lshl_b32 s3, s63, 10
v_lshlrev_b32 v4, 4, v1
buffer_load_dwordx4 v[232:235], v4, s[4:7], s3 offen
L_1:
s_load_dword s65, s[60:61], 0
s_mov_b32 s4, s60
s_mov_b32 s5, s61
s_mov_b32 s6, 4194304
s_mov_b32 s7, 0x20000
s_cmp_eq_u32 s72, 0
s_cbranch_scc1 L_s_noG
s_waitcnt lgkmcnt(0)
s_add_u32 s66, s65, 1
s_mov_b32 s19, 0x3db504f3
s_mov_b32 s20, 0x3fb8aa3b
v_lshrrev_b32 v247, 4, v0
v_lshlrev_b32 v246, 6, v247
v_bfe_u32 v247, v0, 1, 2
v_lshl_add_u32 v246, v247, 4, v246
v_bfe_u32 v247, v0, 3, 1
v_lshl_add_u32 v246, v247, 3, v246
v_and_b32 v247, 1, v0
v_lshl_add_u32 v246, v247, 2, v246
v_add_u32 v246, 12288, v246
v_bfe_u32 v6, v1, 2, 3
v_lshrrev_b32 v7, 1, v6
v_add_u32 v7, s62, v7
v_and_b32 v7, 3, v7
v_lshlrev_b32 v14, 7, v6
v_lshl_add_u32 v14, v7, 5, v14
v_and_b32 v7, 3, v1
v_lshl_add_u32 v14, v7, 3, v14
v_lshrrev_b32 v6, 5, v1
v_lshl_add_u32 v14, v6, 10, v14
v_add_u32 v14, 16384, v14
v_add_u32 v15, 0x10000, v14
v_bfe_u32 v6, v1, 1, 1
v_mul_u32_u24 v6, 1152, v6
v_lshrrev_b32 v7, 4, v1
v_lshl_add_u32 v6, v7, 4, v6
s_waitcnt vmcnt(9)
v_lshlrev_b32 v236, 16, v244
v_and_b32 v237, 0xffff0000, v244
v_mul_f32 v238, s20, v236
v_exp_f32 v238, -v238
s_nop 0
v_add_f32 v238, 1.0, v238
v_rcp_f32 v238, v238
s_nop 0
v_mul_f32 v236, v236, v238
v_mul_f32 v239, s20, v237
v_exp_f32 v239, -v239
s_nop 0
v_add_f32 v239, 1.0, v239
v_rcp_f32 v239, v239
s_nop 0
v_mul_f32 v237, v237, v239
v_cvt_pk_bf16_f32 v244, v236, v237
v_lshlrev_b32 v236, 16, v245
v_and_b32 v237, 0xffff0000, v245
v_mul_f32 v238, s20, v236
v_exp_f32 v238, -v238
s_nop 0
v_add_f32 v238, 1.0, v238
v_rcp_f32 v238, v238
s_nop 0
v_mul_f32 v236, v236, v238
v_mul_f32 v239, s20, v237
v_exp_f32 v239, -v239
s_nop 0
v_add_f32 v239, 1.0, v239
v_rcp_f32 v239, v239
s_nop 0
v_mul_f32 v237, v237, v239
v_cvt_pk_bf16_f32 v245, v236, v237
s_mov_b64 exec, s[76:77]
s_cbranch_execz L_s_nosilu2
ds_write_b32 v246, v244
ds_write_b32 v246, v245 offset:1152
L_s_nosilu2:
s_mov_b64 exec, -1
s_waitcnt vmcnt(0) lgkmcnt(0)
s_barrier
s_cmp_gt_u32 s62, 3
s_cbranch_scc1 L_s_noG
ds_read_b64_tr_b16 v[172:173], v14 offset:0
ds_read_b64_tr_b16 v[174:175], v14 offset:2048
ds_read_b128 v[196:199], v6 offset:12288
ds_read_b64_tr_b16 v[176:177], v14 offset:4096
ds_read_b64_tr_b16 v[178:179], v14 offset:6144
ds_read_b128 v[200:203], v6 offset:12352
ds_read_b64_tr_b16 v[180:181], v14 offset:8192
ds_read_b64_tr_b16 v[182:183], v14 offset:10240
ds_read_b128 v[204:207], v6 offset:12416
ds_read_b64_tr_b16 v[184:185], v14 offset:12288
ds_read_b64_tr_b16 v[186:187], v14 offset:14336
ds_read_b128 v[208:211], v6 offset:12480
s_waitcnt lgkmcnt(9)
v_mfma_f32_16x16x32_bf16 v[232:235], v[196:199], v[172:175], 0
ds_read_b64_tr_b16 v[188:189], v14 offset:16384
ds_read_b64_tr_b16 v[190:191], v14 offset:18432
ds_read_b128 v[212:215], v6 offset:12544
s_waitcnt lgkmcnt(9)
v_mfma_f32_16x16x32_bf16 v[232:235], v[200:203], v[176:179], v[232:235]
ds_read_b64_tr_b16 v[192:193], v14 offset:20480
ds_read_b64_tr_b16 v[194:195], v14 offset:22528
ds_read_b128 v[216:219], v6 offset:12608
s_waitcnt lgkmcnt(9)
v_mfma_f32_16x16x32_bf16 v[232:235], v[204:207], v[180:183], v[232:235]
ds_read_b64_tr_b16 v[172:173], v14 offset:24576
ds_read_b64_tr_b16 v[174:175], v14 offset:26624
ds_read_b128 v[196:199], v6 offset:12672
s_waitcnt lgkmcnt(9)
v_mfma_f32_16x16x32_bf16 v[232:235], v[208:211], v[184:187], v[232:235]
ds_read_b64_tr_b16 v[176:177], v14 offset:28672
ds_read_b64_tr_b16 v[178:179], v14 offset:30720
ds_read_b128 v[200:203], v6 offset:12736
s_waitcnt lgkmcnt(9)
v_mfma_f32_16x16x32_bf16 v[232:235], v[212:215], v[188:191], v[232:235]
ds_read_b64_tr_b16 v[180:181], v14 offset:32768
ds_read_b64_tr_b16 v[182:183], v14 offset:34816
ds_read_b128 v[204:207], v6 offset:12800
s_waitcnt lgkmcnt(9)
v_mfma_f32_16x16x32_bf16 v[232:235], v[216:219], v[192:195], v[232:235]
ds_read_b64_tr_b16 v[184:185], v14 offset:36864
ds_read_b64_tr_b16 v[186:187], v14 offset:38912
ds_read_b128 v[208:211], v6 offset:12864
s_waitcnt lgkmcnt(9)
v_mfma_f32_16x16x32_bf16 v[232:235], v[196:199], v[172:175], v[232:235]
ds_read_b64_tr_b16 v[188:189], v14 offset:40960
ds_read_b64_tr_b16 v[190:191], v14 offset:43008
ds_read_b128 v[212:215], v6 offset:12928
s_waitcnt lgkmcnt(9)
v_mfma_f32_16x16x32_bf16 v[232:235], v[200:203], v[176:179], v[232:235]
ds_read_b64_tr_b16 v[192:193], v14 offset:45056
ds_read_b64_tr_b16 v[194:195], v14 offset:47104
ds_read_b128 v[216:219], v6 offset:12992
s_waitcnt lgkmcnt(9)
v_mfma_f32_16x16x32_bf16 v[232:235], v[204:207], v[180:183], v[232:235]
ds_read_b64_tr_b16 v[172:173], v14 offset:49152
ds_read_b64_tr_b16 v[174:175], v14 offset:51200
ds_read_b128 v[196:199], v6 offset:13056
s_waitcnt lgkmcnt(9)
v_mfma_f32_16x16x32_bf16 v[232:235], v[208:211], v[184:187], v[232:235]
ds_read_b64_tr_b16 v[176:177], v14 offset:53248
ds_read_b64_tr_b16 v[178:179], v14 offset:55296
ds_read_b128 v[200:203], v6 offset:13120
s_waitcnt lgkmcnt(9)
v_mfma_f32_16x16x32_bf16 v[232:235], v[212:215], v[188:191], v[232:235]
ds_read_b64_tr_b16 v[180:181], v14 offset:57344
ds_read_b64_tr_b16 v[182:183], v14 offset:59392
ds_read_b128 v[204:207], v6 offset:13184
s_waitcnt lgkmcnt(9)
v_mfma_f32_16x16x32_bf16 v[232:235], v[216:219], v[192:195], v[232:235]
ds_read_b64_tr_b16 v[184:185], v14 offset:61440
ds_read_b64_tr_b16 v[186:187], v14 offset:63488
ds_read_b128 v[208:211], v6 offset:13248
s_waitcnt lgkmcnt(9)
v_mfma_f32_16x16x32_bf16 v[232:235], v[196:199], v[172:175], v[232:235]
ds_read_b64_tr_b16 v[188:189], v15 offset:0
ds_read_b64_tr_b16 v[190:191], v15 offset:2048
ds_read_b128 v[212:215], v6 offset:13312
s_waitcnt lgkmcnt(9)
v_mfma_f32_16x16x32_bf16 v[232:235], v[200:203], v[176:179], v[232:235]
ds_read_b64_tr_b16 v[192:193], v15 offset:4096
ds_read_b64_tr_b16 v[194:195], v15 offset:6144
ds_read_b128 v[216:219], v6 offset:13376
s_waitcnt lgkmcnt(9)
v_mfma_f32_16x16x32_bf16 v[232:235], v[204:207], v[180:183], v[232:235]
s_waitcnt lgkmcnt(6)
v_mfma_f32_16x16x32_bf16 v[232:235], v[208:211], v[184:187], v[232:235]
s_waitcnt lgkmcnt(3)
v_mfma_f32_16x16x32_bf16 v[232:235], v[212:215], v[188:191], v[232:235]
s_waitcnt lgkmcnt(0)
v_mfma_f32_16x16x32_bf16 v[232:235], v[216:219], v[192:195], v[232:235]
s_lshl_b32 s22, s75, 9
s_lshl_b32 s23, s62, 7
s_add_u32 s22, s22, s23
s_add_u32 s22, s22, 4096
v_cmp_gt_u32 vcc, 16, v1
v_lshlrev_b32 v6, 3, v1
v_mov_b32 v7, 2147483648
v_cndmask_b32 v6, v7, v6, vcc
v_cvt_pk_bf16_f32 v232, v232, v234
v_mov_b32 v233, s66
buffer_store_dwordx2 v[232:233], v6, s[4:7], s22 offen sc1
L_s_noG:
buffer_load_dwordx4 v[24:27], v2, s[8:11], s16 offen offset:2048 nt
buffer_load_dwordx4 v[28:31], v2, s[8:11], s16 offen offset:3072 nt
s_add_u32 s17, s16, 4096
buffer_load_dwordx4 v[32:35], v2, s[8:11], s17 offen nt
s_add_u32 s17, s16, 5120
buffer_load_dwordx4 v[36:39], v2, s[8:11], s17 offen nt
v_lshlrev_b32 v3, 4, v1
s_mov_b32 s12, s36
s_mov_b32 s13, s37
s_mov_b32 s14, 67108864
s_mov_b32 s15, 0x20000
s_mov_b32 s18, 0x6d472100
s_mov_b32 s19, 0xdab48e
s_cmp_ge_u32 s63, 22
s_cselect_b32 s18, 0x6c472200, s18
s_cselect_b32 s19, 0xdbb691, s19
s_lshl_b32 s17, s64, 3
s_lshr_b64 s[18:19], s[18:19], s17
s_and_b32 s20, s18, 0xff
s_lshr_b32 s27, s18, 8
s_sub_u32 s27, s27, s20
s_and_b32 s27, s27, 0xff
s_mov_b32 s18, 0x1011100
s_mov_b32 s19, 0x101110
s_lshl_b32 s17, s24, 2
s_lshr_b64 s[18:19], s[18:19], s17
s_and_b32 s21, s18, 15
s_lshl_b32 s17, s64, 2
s_lshr_b64 s[18:19], s[18:19], s17
s_and_b32 s17, s18, 15
s_bfe_u32 s18, s18, 0x40004
s_add_u32 s20, s20, s17
s_sub_u32 s20, s20, s21
s_add_u32 s27, s27, s18
s_sub_u32 s27, s27, s17
s_mul_i32 s17, s64, 26
s_sub_u32 s20, s20, s17
s_lshl_b32 s20, s20, 3
s_sub_u32 s17, s27, 26
s_mul_i32 s17, s17, s62
s_add_u32 s20, s20, s17
s_add_u32 s20, s20, 1430
s_lshl_b32 s17, s63, 21
s_lshl_b32 s25, s20, 10
s_add_u32 s25, s25, s17
s_mov_b32 s78, 0x7f800000
s_mov_b32 s79, 0xff800000
s_waitcnt lgkmcnt(0)
s_add_u32 s66, s65, 1
s_mov_b32 s19, 0x3db504f3
s_mov_b32 s20, 0x3fb8aa3b
v_and_b32 v6, 1, v1
v_mov_b32 v7, 0xffff
v_lshlrev_b32 v6, 4, v6
v_lshlrev_b32 v7, v6, v7
v_bfe_u32 v6, v1, 1, 2
v_cmp_eq_u32 vcc, 0, v6
s_nop 1
v_cndmask_b32 v10, 0, v7, vcc
v_cmp_eq_u32 vcc, 1, v6
s_nop 1
v_cndmask_b32 v11, 0, v7, vcc
v_cmp_eq_u32 vcc, 2, v6
s_nop 1
v_cndmask_b32 v12, 0, v7, vcc
v_cmp_eq_u32 vcc, 3, v6
s_nop 1
v_cndmask_b32 v13, 0, v7, vcc
s_and_b32 s21, s63, 15
s_lshl_b32 s21, s21, 11
s_add_u32 s21, s21, 32768
s_cmp_lt_u32 s63, 16
s_cselect_b32 s24, 0, 0x02020202
s_add_u32 s24, s24, 0x05040100
v_mov_b32 v8, 0xff800000
v_mov_b32 v9, 0
v_mov_b32 v252, 0
v_mov_b32 v253, 0
v_mov_b32 v254, 0
v_mov_b32 v255, 0
s_waitcnt vmcnt(5)
s_add_u32 s17, s16, 6144
buffer_load_dwordx4 v[40:43], v2, s[8:11], s17 offen nt
s_waitcnt vmcnt(5)
s_add_u32 s17, s16, 7168
buffer_load_dwordx4 v[44:47], v2, s[8:11], s17 offen nt
s_waitcnt vmcnt(5)
s_add_u32 s17, s16, 8192
buffer_load_dwordx4 v[48:51], v2, s[8:11], s17 offen nt
s_waitcnt vmcnt(5)
s_add_u32 s17, s16, 9216
buffer_load_dwordx4 v[52:55], v2, s[8:11], s17 offen nt
s_waitcnt vmcnt(5)
s_add_u32 s17, s16, 10240
buffer_load_dwordx4 v[56:59], v2, s[8:11], s17 offen nt
s_waitcnt vmcnt(5)
s_add_u32 s17, s16, 11264
buffer_load_dwordx4 v[60:63], v2, s[8:11], s17 offen nt
s_waitcnt vmcnt(5)
s_add_u32 s17, s16, 12288
buffer_load_dwordx4 v[64:67], v2, s[8:11], s17 offen nt
s_waitcnt vmcnt(5)
s_add_u32 s17, s16, 13312
buffer_load_dwordx4 v[68:71], v2, s[8:11], s17 offen nt
s_waitcnt vmcnt(5)
s_add_u32 s17, s16, 14336
buffer_load_dwordx4 v[72:75], v2, s[8:11], s17 offen nt
s_waitcnt vmcnt(5)
s_add_u32 s17, s16, 15360
buffer_load_dwordx4 v[76:79], v2, s[8:11], s17 offen nt
s_waitcnt vmcnt(5)
s_add_u32 s17, s16, 16384
buffer_load_dwordx4 v[80:83], v2, s[8:11], s17 offen nt
s_waitcnt vmcnt(5)
s_add_u32 s17, s16, 17408
buffer_load_dwordx4 v[84:87], v2, s[8:11], s17 offen nt
s_waitcnt vmcnt(5)
s_add_u32 s17, s16, 18432
buffer_load_dwordx4 v[88:91], v2, s[8:11], s17 offen nt
s_waitcnt vmcnt(5)
s_add_u32 s17, s16, 19456
buffer_load_dwordx4 v[92:95], v2, s[8:11], s17 offen nt
s_waitcnt vmcnt(5)
s_add_u32 s17, s16, 20480
buffer_load_dwordx4 v[96:99], v2, s[8:11], s17 offen nt
s_waitcnt vmcnt(5)
s_add_u32 s17, s16, 21504
buffer_load_dwordx4 v[100:103], v2, s[8:11], s17 offen nt
s_waitcnt vmcnt(5)
s_add_u32 s17, s16, 22528
buffer_load_dwordx4 v[104:107], v2, s[8:11], s17 offen nt
s_waitcnt vmcnt(5)
s_add_u32 s17, s16, 23552
buffer_load_dwordx4 v[108:111], v2, s[8:11], s17 offen nt
s_waitcnt vmcnt(5)
s_add_u32 s17, s16, 24576
buffer_load_dwordx4 v[112:115], v2, s[8:11], s17 offen nt
s_waitcnt vmcnt(5)
s_add_u32 s17, s16, 25600
buffer_load_dwordx4 v[116:119], v2, s[8:11], s17 offen nt
s_waitcnt vmcnt(5)
s_add_u32 s17, s25, 26624
buffer_load_dwordx4 v[120:123], v2, s[8:11], s17 offen nt
s_waitcnt vmcnt(5)
s_add_u32 s17, s25, 27648
buffer_load_dwordx4 v[124:127], v2, s[8:11], s17 offen nt
s_waitcnt vmcnt(5)
s_add_u32 s17, s25, 28672
buffer_load_dwordx4 v[128:131], v2, s[8:11], s17 offen nt
s_waitcnt vmcnt(5)
s_add_u32 s17, s25, 29696
buffer_load_dwordx4 v[132:135], v2, s[8:11], s17 offen nt
s_waitcnt vmcnt(5)
s_add_u32 s17, s25, 30720
buffer_load_dwordx4 v[136:139], v2, s[8:11], s17 offen nt
s_waitcnt vmcnt(5)
s_add_u32 s17, s25, 31744
buffer_load_dwordx4 v[140:143], v2, s[8:11], s17 offen nt
s_waitcnt vmcnt(5)
s_cmp_gt_u32 s27, 32
s_cselect_b32 s17, 0, 2147483648
v_or_b32 v4, s17, v2
s_add_u32 s17, s25, 32768
buffer_load_dwordx4 v[144:147], v4, s[8:11], s17 offen nt
s_waitcnt vmcnt(5)
s_cmp_gt_u32 s27, 33
s_cselect_b32 s17, 0, 2147483648
v_or_b32 v4, s17, v2
s_add_u32 s17, s25, 33792
buffer_load_dwordx4 v[148:151], v4, s[8:11], s17 offen nt
s_waitcnt vmcnt(5)
s_cmp_gt_u32 s27, 34
s_cselect_b32 s17, 0, 2147483648
v_or_b32 v4, s17, v2
s_add_u32 s17, s25, 34816
buffer_load_dwordx4 v[152:155], v4, s[8:11], s17 offen nt
s_waitcnt vmcnt(5)
s_cmp_gt_u32 s27, 35
s_cselect_b32 s17, 0, 2147483648
v_or_b32 v4, s17, v2
s_add_u32 s17, s25, 35840
buffer_load_dwordx4 v[156:159], v4, s[8:11], s17 offen nt
s_waitcnt vmcnt(5)
s_cmp_gt_u32 s27, 36
s_cselect_b32 s17, 0, 2147483648
v_or_b32 v4, s17, v2
s_add_u32 s17, s25, 36864
buffer_load_dwordx4 v[160:163], v4, s[8:11], s17 offen nt
s_waitcnt vmcnt(5)
s_cmp_gt_u32 s27, 37
s_cselect_b32 s17, 0, 2147483648
v_or_b32 v4, s17, v2
s_add_u32 s17, s25, 37888
buffer_load_dwordx4 v[164:167], v4, s[8:11], s17 offen nt
s_waitcnt vmcnt(5)
s_cmp_gt_u32 s27, 38
s_cselect_b32 s17, 0, 2147483648
v_or_b32 v4, s17, v2
s_add_u32 s17, s25, 38912
buffer_load_dwordx4 v[168:171], v4, s[8:11], s17 offen nt
s_waitcnt vmcnt(5)
s_cmp_lg_u32 s62, 0
s_cbranch_scc0 L_s_w0
s_add_u32 s17, s16, 0
buffer_load_dwordx4 v[172:175], v3, s[12:15], s17 offen nt
s_add_u32 s17, s16, 1024
buffer_load_dwordx4 v[176:179], v3, s[12:15], s17 offen nt
s_add_u32 s17, s16, 2048
buffer_load_dwordx4 v[180:183], v3, s[12:15], s17 offen nt
s_add_u32 s17, s16, 3072
buffer_load_dwordx4 v[184:187], v3, s[12:15], s17 offen nt
s_add_u32 s17, s16, 4096
buffer_load_dwordx4 v[188:191], v3, s[12:15], s17 offen nt
s_add_u32 s17, s16, 5120
buffer_load_dwordx4 v[192:195], v3, s[12:15], s17 offen nt
s_add_u32 s17, s16, 6144
buffer_load_dwordx4 v[196:199], v3, s[12:15], s17 offen nt
s_add_u32 s17, s16, 7168
buffer_load_dwordx4 v[200:203], v3, s[12:15], s17 offen nt
s_add_u32 s17, s16, 8192
buffer_load_dwordx4 v[204:207], v3, s[12:15], s17 offen nt
s_add_u32 s17, s16, 9216
buffer_load_dwordx4 v[208:211], v3, s[12:15], s17 offen nt
s_add_u32 s17, s16, 10240
buffer_load_dwordx4 v[212:215], v3, s[12:15], s17 offen nt
s_add_u32 s17, s16, 11264
buffer_load_dwordx4 v[216:219], v3, s[12:15], s17 offen nt
s_add_u32 s17, s16, 12288
buffer_load_dwordx4 v[220:223], v3, s[12:15], s17 offen nt
s_waitcnt vmcnt(13)
s_branch L_s_qdone
L_s_w0:
buffer_load_dwordx4 v[236:239], v3, s[4:7], s21 offen sc1
buffer_load_dwordx4 v[240:243], v3, s[4:7], s21 offen offset:1024 sc1
s_add_u32 s17, s16, 0
buffer_load_dwordx4 v[172:175], v3, s[12:15], s17 offen nt
s_add_u32 s17, s16, 1024
buffer_load_dwordx4 v[176:179], v3, s[12:15], s17 offen nt
s_add_u32 s17, s16, 2048
buffer_load_dwordx4 v[180:183], v3, s[12:15], s17 offen nt
s_add_u32 s17, s16, 3072
buffer_load_dwordx4 v[184:187], v3, s[12:15], s17 offen nt
s_add_u32 s17, s16, 4096
buffer_load_dwordx4 v[188:191], v3, s[12:15], s17 offen nt
s_add_u32 s17, s16, 5120
buffer_load_dwordx4 v[192:195], v3, s[12:15], s17 offen nt
s_waitcnt vmcnt(10)
buffer_load_dwordx4 v[224:227], v3, s[4:7], s21 offen sc1
buffer_load_dwordx4 v[228:231], v3, s[4:7], s21 offen offset:1024 sc1
s_add_u32 s17, s16, 6144
buffer_load_dwordx4 v[196:199], v3, s[12:15], s17 offen nt
s_add_u32 s17, s16, 7168
buffer_load_dwordx4 v[200:203], v3, s[12:15], s17 offen nt
s_add_u32 s17, s16, 8192
buffer_load_dwordx4 v[204:207], v3, s[12:15], s17 offen nt
s_add_u32 s17, s16, 9216
buffer_load_dwordx4 v[208:211], v3, s[12:15], s17 offen nt
s_add_u32 s17, s16, 10240
buffer_load_dwordx4 v[212:215], v3, s[12:15], s17 offen nt
s_add_u32 s17, s16, 11264
buffer_load_dwordx4 v[216:219], v3, s[12:15], s17 offen nt
s_add_u32 s17, s16, 12288
buffer_load_dwordx4 v[220:223], v3, s[12:15], s17 offen nt
s_waitcnt vmcnt(15)
v_cmp_ne_u32 vcc, s66, v237
v_cmp_ne_u32 s[22:23], s66, v239
s_nop 0
s_or_b64 vcc, vcc, s[22:23]
v_cmp_ne_u32 s[22:23], s66, v241
s_nop 0
s_or_b64 vcc, vcc, s[22:23]
v_cmp_ne_u32 s[22:23], s66, v243
s_nop 0
s_or_b64 vcc, vcc, s[22:23]
s_cbranch_vccz L_s_qok
s_waitcnt vmcnt(7)
v_mov_b32 v236, v224
v_mov_b32 v237, v225
v_mov_b32 v238, v226
v_mov_b32 v239, v227
v_mov_b32 v240, v228
v_mov_b32 v241, v229
v_mov_b32 v242, v230
v_mov_b32 v243, v231
s_mov_b32 s67, 0
L_s_qchk:
v_cmp_ne_u32 vcc, s66, v237
v_cmp_ne_u32 s[22:23], s66, v239
s_nop 0
s_or_b64 vcc, vcc, s[22:23]
v_cmp_ne_u32 s[22:23], s66, v241
s_nop 0
s_or_b64 vcc, vcc, s[22:23]
v_cmp_ne_u32 s[22:23], s66, v243
s_nop 0
s_or_b64 vcc, vcc, s[22:23]
s_cbranch_vccz L_s_qok
s_add_u32 s67, s67, 1
s_cmp_gt_u32 s67, 262144
s_cbranch_scc1 L_s_qok
s_sleep 2
buffer_load_dwordx4 v[236:239], v3, s[4:7], s21 offen sc1
buffer_load_dwordx4 v[240:243], v3, s[4:7], s21 offen offset:1024 sc1
s_waitcnt vmcnt(0)
s_branch L_s_qchk
L_s_qok:
v_perm_b32 v6, v238, v236, s24
v_perm_b32 v7, v242, v240, s24
v_lshlrev_b32 v14, 2, v1
ds_write_b32 v14, v6 offset:0
ds_write_b32 v14, v7 offset:256
L_s_qdone:
s_add_u32 s17, s16, 13312
buffer_load_dwordx4 v[224:227], v3, s[12:15], s17 offen nt
s_add_u32 s17, s16, 14336
buffer_load_dwordx4 v[228:231], v3, s[12:15], s17 offen nt
v_bfe_u32 v6, v1, 3, 1
v_lshlrev_b32 v6, 8, v6
v_lshrrev_b32 v7, 4, v1
v_lshl_add_u32 v6, v7, 6, v6
v_and_b32 v7, 3, v1
v_lshl_add_u32 v6, v7, 4, v6
s_waitcnt lgkmcnt(0)
s_barrier
ds_read_b128 v[232:235], v6 offset:0
s_waitcnt lgkmcnt(0)
v_mfma_f32_16x16x32_bf16 v[236:239], v[16:19], v[232:235], 0
v_mfma_f32_16x16x32_bf16 v[240:243], v[20:23], v[232:235], 0
v_mfma_f32_16x16x32_bf16 v[244:247], v[24:27], v[232:235], 0
v_mfma_f32_16x16x32_bf16 v[248:251], v[28:31], v[232:235], 0
s_nop 4
v_mov_b32_dpp v6, v236 quad_perm:[0,0,0,0] row_mask:0xf bank_mask:0xf
v_mov_b32_dpp v7, v240 quad_perm:[0,0,0,0] row_mask:0xf bank_mask:0xf
s_nop 0
v_add_f32_dpp v6, v237, v6 quad_perm:[1,1,1,1] row_mask:0xf bank_mask:0xf
v_add_f32_dpp v7, v241, v7 quad_perm:[1,1,1,1] row_mask:0xf bank_mask:0xf
s_nop 0
v_add_f32_dpp v6, v238, v6 quad_perm:[2,2,2,2] row_mask:0xf bank_mask:0xf
v_add_f32_dpp v7, v242, v7 quad_perm:[2,2,2,2] row_mask:0xf bank_mask:0xf
s_nop 0
v_add_f32_dpp v6, v239, v6 quad_perm:[3,3,3,3] row_mask:0xf bank_mask:0xf
v_add_f32_dpp v7, v243, v7 quad_perm:[3,3,3,3] row_mask:0xf bank_mask:0xf
v_mfma_f32_16x16x32_bf16 v[236:239], v[32:35], v[232:235], 0
v_mfma_f32_16x16x32_bf16 v[240:243], v[36:39], v[232:235], 0
v_mov_b32_dpp v14, v244 quad_perm:[0,0,0,0] row_mask:0xf bank_mask:0xf
v_mov_b32_dpp v15, v248 quad_perm:[0,0,0,0] row_mask:0xf bank_mask:0xf
v_cvt_pk_bf16_f32 v2, v6, v7
v_lshlrev_b32 v6, 16, v2
v_add_f32_dpp v14, v245, v14 quad_perm:[1,1,1,1] row_mask:0xf bank_mask:0xf
v_add_f32_dpp v15, v249, v15 quad_perm:[1,1,1,1] row_mask:0xf bank_mask:0xf
v_and_b32 v7, 0xffff0000, v2
v_mul_f32 v6, s19, v6
v_add_f32_dpp v14, v246, v14 quad_perm:[2,2,2,2] row_mask:0xf bank_mask:0xf
v_add_f32_dpp v15, v250, v15 quad_perm:[2,2,2,2] row_mask:0xf bank_mask:0xf
v_mul_f32 v7, s19, v7
v_cvt_pk_bf16_f32 v2, v6, v7
v_add_f32_dpp v14, v247, v14 quad_perm:[3,3,3,3] row_mask:0xf bank_mask:0xf
v_add_f32_dpp v15, v251, v15 quad_perm:[3,3,3,3] row_mask:0xf bank_mask:0xf
v_lshlrev_b32 v16, 16, v2
v_and_b32 v17, 0xffff0000, v2
v_max3_f32 v8, v8, v16, v17
v_mfma_f32_16x16x32_bf16 v[244:247], v[40:43], v[232:235], 0
v_mfma_f32_16x16x32_bf16 v[248:251], v[44:47], v[232:235], 0
v_mov_b32_dpp v6, v236 quad_perm:[0,0,0,0] row_mask:0xf bank_mask:0xf
v_mov_b32_dpp v7, v240 quad_perm:[0,0,0,0] row_mask:0xf bank_mask:0xf
v_cvt_pk_bf16_f32 v2, v14, v15
v_lshlrev_b32 v14, 16, v2
v_add_f32_dpp v6, v237, v6 quad_perm:[1,1,1,1] row_mask:0xf bank_mask:0xf
v_add_f32_dpp v7, v241, v7 quad_perm:[1,1,1,1] row_mask:0xf bank_mask:0xf
v_and_b32 v15, 0xffff0000, v2
v_mul_f32 v14, s19, v14
v_add_f32_dpp v6, v238, v6 quad_perm:[2,2,2,2] row_mask:0xf bank_mask:0xf
v_add_f32_dpp v7, v242, v7 quad_perm:[2,2,2,2] row_mask:0xf bank_mask:0xf
v_mul_f32 v15, s19, v15
v_cvt_pk_bf16_f32 v2, v14, v15
v_add_f32_dpp v6, v239, v6 quad_perm:[3,3,3,3] row_mask:0xf bank_mask:0xf
v_add_f32_dpp v7, v243, v7 quad_perm:[3,3,3,3] row_mask:0xf bank_mask:0xf
v_lshlrev_b32 v18, 16, v2
v_and_b32 v19, 0xffff0000, v2
v_max3_f32 v8, v8, v18, v19
v_mfma_f32_16x16x32_bf16 v[236:239], v[48:51], v[232:235], 0
v_mfma_f32_16x16x32_bf16 v[240:243], v[52:55], v[232:235], 0
v_mov_b32_dpp v14, v244 quad_perm:[0,0,0,0] row_mask:0xf bank_mask:0xf
v_mov_b32_dpp v15, v248 quad_perm:[0,0,0,0] row_mask:0xf bank_mask:0xf
v_cvt_pk_bf16_f32 v2, v6, v7
v_lshlrev_b32 v6, 16, v2
v_add_f32_dpp v14, v245, v14 quad_perm:[1,1,1,1] row_mask:0xf bank_mask:0xf
v_add_f32_dpp v15, v249, v15 quad_perm:[1,1,1,1] row_mask:0xf bank_mask:0xf
v_and_b32 v7, 0xffff0000, v2
v_mul_f32 v6, s19, v6
v_add_f32_dpp v14, v246, v14 quad_perm:[2,2,2,2] row_mask:0xf bank_mask:0xf
v_add_f32_dpp v15, v250, v15 quad_perm:[2,2,2,2] row_mask:0xf bank_mask:0xf
v_mul_f32 v7, s19, v7
v_cvt_pk_bf16_f32 v2, v6, v7
v_add_f32_dpp v14, v247, v14 quad_perm:[3,3,3,3] row_mask:0xf bank_mask:0xf
v_add_f32_dpp v15, v251, v15 quad_perm:[3,3,3,3] row_mask:0xf bank_mask:0xf
v_lshlrev_b32 v20, 16, v2
v_and_b32 v21, 0xffff0000, v2
v_max3_f32 v8, v8, v20, v21
v_mfma_f32_16x16x32_bf16 v[244:247], v[56:59], v[232:235], 0
s_add_u32 s17, s16, 15360
buffer_load_dwordx4 v[56:59], v3, s[12:15], s17 offen nt
v_mfma_f32_16x16x32_bf16 v[248:251], v[60:63], v[232:235], 0
v_mov_b32_dpp v6, v236 quad_perm:[0,0,0,0] row_mask:0xf bank_mask:0xf
v_mov_b32_dpp v7, v240 quad_perm:[0,0,0,0] row_mask:0xf bank_mask:0xf
v_cvt_pk_bf16_f32 v2, v14, v15
v_lshlrev_b32 v14, 16, v2
v_add_f32_dpp v6, v237, v6 quad_perm:[1,1,1,1] row_mask:0xf bank_mask:0xf
v_add_f32_dpp v7, v241, v7 quad_perm:[1,1,1,1] row_mask:0xf bank_mask:0xf
v_and_b32 v15, 0xffff0000, v2
v_mul_f32 v14, s19, v14
v_add_f32_dpp v6, v238, v6 quad_perm:[2,2,2,2] row_mask:0xf bank_mask:0xf
v_add_f32_dpp v7, v242, v7 quad_perm:[2,2,2,2] row_mask:0xf bank_mask:0xf
v_mul_f32 v15, s19, v15
v_cvt_pk_bf16_f32 v2, v14, v15
v_add_f32_dpp v6, v239, v6 quad_perm:[3,3,3,3] row_mask:0xf bank_mask:0xf
v_add_f32_dpp v7, v243, v7 quad_perm:[3,3,3,3] row_mask:0xf bank_mask:0xf
v_lshlrev_b32 v22, 16, v2
v_and_b32 v23, 0xffff0000, v2
v_max3_f32 v8, v8, v22, v23
v_mfma_f32_16x16x32_bf16 v[236:239], v[64:67], v[232:235], 0
v_mfma_f32_16x16x32_bf16 v[240:243], v[68:71], v[232:235], 0
s_add_u32 s17, s16, 16384
buffer_load_dwordx4 v[60:63], v3, s[12:15], s17 offen nt
v_mov_b32_dpp v14, v244 quad_perm:[0,0,0,0] row_mask:0xf bank_mask:0xf
v_mov_b32_dpp v15, v248 quad_perm:[0,0,0,0] row_mask:0xf bank_mask:0xf
v_cvt_pk_bf16_f32 v2, v6, v7
v_lshlrev_b32 v6, 16, v2
v_add_f32_dpp v14, v245, v14 quad_perm:[1,1,1,1] row_mask:0xf bank_mask:0xf
v_add_f32_dpp v15, v249, v15 quad_perm:[1,1,1,1] row_mask:0xf bank_mask:0xf
v_and_b32 v7, 0xffff0000, v2
v_mul_f32 v6, s19, v6
v_add_f32_dpp v14, v246, v14 quad_perm:[2,2,2,2] row_mask:0xf bank_mask:0xf
v_add_f32_dpp v15, v250, v15 quad_perm:[2,2,2,2] row_mask:0xf bank_mask:0xf
v_mul_f32 v7, s19, v7
v_cvt_pk_bf16_f32 v2, v6, v7
v_add_f32_dpp v14, v247, v14 quad_perm:[3,3,3,3] row_mask:0xf bank_mask:0xf
v_add_f32_dpp v15, v251, v15 quad_perm:[3,3,3,3] row_mask:0xf bank_mask:0xf
v_lshlrev_b32 v24, 16, v2
v_and_b32 v25, 0xffff0000, v2
v_max3_f32 v8, v8, v24, v25
v_mfma_f32_16x16x32_bf16 v[244:247], v[72:75], v[232:235], 0
v_mfma_f32_16x16x32_bf16 v[248:251], v[76:79], v[232:235], 0
v_mov_b32_dpp v6, v236 quad_perm:[0,0,0,0] row_mask:0xf bank_mask:0xf
v_mov_b32_dpp v7, v240 quad_perm:[0,0,0,0] row_mask:0xf bank_mask:0xf
v_cvt_pk_bf16_f32 v2, v14, v15
v_lshlrev_b32 v14, 16, v2
v_add_f32_dpp v6, v237, v6 quad_perm:[1,1,1,1] row_mask:0xf bank_mask:0xf
v_add_f32_dpp v7, v241, v7 quad_perm:[1,1,1,1] row_mask:0xf bank_mask:0xf
v_and_b32 v15, 0xffff0000, v2
v_mul_f32 v14, s19, v14
v_add_f32_dpp v6, v238, v6 quad_perm:[2,2,2,2] row_mask:0xf bank_mask:0xf
v_add_f32_dpp v7, v242, v7 quad_perm:[2,2,2,2] row_mask:0xf bank_mask:0xf
v_mul_f32 v15, s19, v15
v_cvt_pk_bf16_f32 v2, v14, v15
v_add_f32_dpp v6, v239, v6 quad_perm:[3,3,3,3] row_mask:0xf bank_mask:0xf
v_add_f32_dpp v7, v243, v7 quad_perm:[3,3,3,3] row_mask:0xf bank_mask:0xf
v_lshlrev_b32 v26, 16, v2
v_and_b32 v27, 0xffff0000, v2
v_max3_f32 v8, v8, v26, v27
v_mfma_f32_16x16x32_bf16 v[236:239], v[80:83], v[232:235], 0
s_add_u32 s17, s16, 17408
buffer_load_dwordx4 v[64:67], v3, s[12:15], s17 offen nt
v_mfma_f32_16x16x32_bf16 v[240:243], v[84:87], v[232:235], 0
v_mov_b32_dpp v14, v244 quad_perm:[0,0,0,0] row_mask:0xf bank_mask:0xf
v_mov_b32_dpp v15, v248 quad_perm:[0,0,0,0] row_mask:0xf bank_mask:0xf
v_cvt_pk_bf16_f32 v2, v6, v7
v_lshlrev_b32 v6, 16, v2
v_add_f32_dpp v14, v245, v14 quad_perm:[1,1,1,1] row_mask:0xf bank_mask:0xf
v_add_f32_dpp v15, v249, v15 quad_perm:[1,1,1,1] row_mask:0xf bank_mask:0xf
v_and_b32 v7, 0xffff0000, v2
v_mul_f32 v6, s19, v6
v_add_f32_dpp v14, v246, v14 quad_perm:[2,2,2,2] row_mask:0xf bank_mask:0xf
v_add_f32_dpp v15, v250, v15 quad_perm:[2,2,2,2] row_mask:0xf bank_mask:0xf
v_mul_f32 v7, s19, v7
v_cvt_pk_bf16_f32 v2, v6, v7
v_add_f32_dpp v14, v247, v14 quad_perm:[3,3,3,3] row_mask:0xf bank_mask:0xf
v_add_f32_dpp v15, v251, v15 quad_perm:[3,3,3,3] row_mask:0xf bank_mask:0xf
v_lshlrev_b32 v28, 16, v2
v_and_b32 v29, 0xffff0000, v2
v_max3_f32 v8, v8, v28, v29
v_mfma_f32_16x16x32_bf16 v[244:247], v[88:91], v[232:235], 0
v_mfma_f32_16x16x32_bf16 v[248:251], v[92:95], v[232:235], 0
s_add_u32 s17, s16, 18432
buffer_load_dwordx4 v[68:71], v3, s[12:15], s17 offen nt
v_mov_b32_dpp v6, v236 quad_perm:[0,0,0,0] row_mask:0xf bank_mask:0xf
v_mov_b32_dpp v7, v240 quad_perm:[0,0,0,0] row_mask:0xf bank_mask:0xf
v_cvt_pk_bf16_f32 v2, v14, v15
v_lshlrev_b32 v14, 16, v2
v_add_f32_dpp v6, v237, v6 quad_perm:[1,1,1,1] row_mask:0xf bank_mask:0xf
v_add_f32_dpp v7, v241, v7 quad_perm:[1,1,1,1] row_mask:0xf bank_mask:0xf
v_and_b32 v15, 0xffff0000, v2
v_mul_f32 v14, s19, v14
v_add_f32_dpp v6, v238, v6 quad_perm:[2,2,2,2] row_mask:0xf bank_mask:0xf
v_add_f32_dpp v7, v242, v7 quad_perm:[2,2,2,2] row_mask:0xf bank_mask:0xf
v_mul_f32 v15, s19, v15
v_cvt_pk_bf16_f32 v2, v14, v15
v_add_f32_dpp v6, v239, v6 quad_perm:[3,3,3,3] row_mask:0xf bank_mask:0xf
v_add_f32_dpp v7, v243, v7 quad_perm:[3,3,3,3] row_mask:0xf bank_mask:0xf
v_lshlrev_b32 v30, 16, v2
v_and_b32 v31, 0xffff0000, v2
v_max3_f32 v8, v8, v30, v31
v_mfma_f32_16x16x32_bf16 v[236:239], v[96:99], v[232:235], 0
v_mfma_f32_16x16x32_bf16 v[240:243], v[100:103], v[232:235], 0
v_mov_b32_dpp v14, v244 quad_perm:[0,0,0,0] row_mask:0xf bank_mask:0xf
v_mov_b32_dpp v15, v248 quad_perm:[0,0,0,0] row_mask:0xf bank_mask:0xf
v_cvt_pk_bf16_f32 v2, v6, v7
v_lshlrev_b32 v6, 16, v2
v_add_f32_dpp v14, v245, v14 quad_perm:[1,1,1,1] row_mask:0xf bank_mask:0xf
v_add_f32_dpp v15, v249, v15 quad_perm:[1,1,1,1] row_mask:0xf bank_mask:0xf
v_and_b32 v7, 0xffff0000, v2
v_mul_f32 v6, s19, v6
v_add_f32_dpp v14, v246, v14 quad_perm:[2,2,2,2] row_mask:0xf bank_mask:0xf
v_add_f32_dpp v15, v250, v15 quad_perm:[2,2,2,2] row_mask:0xf bank_mask:0xf
v_mul_f32 v7, s19, v7
v_cvt_pk_bf16_f32 v2, v6, v7
v_add_f32_dpp v14, v247, v14 quad_perm:[3,3,3,3] row_mask:0xf bank_mask:0xf
v_add_f32_dpp v15, v251, v15 quad_perm:[3,3,3,3] row_mask:0xf bank_mask:0xf
v_lshlrev_b32 v32, 16, v2
v_and_b32 v33, 0xffff0000, v2
v_max3_f32 v8, v8, v32, v33
v_mfma_f32_16x16x32_bf16 v[244:247], v[104:107], v[232:235], 0
v_mfma_f32_16x16x32_bf16 v[248:251], v[108:111], v[232:235], 0
v_mov_b32_dpp v6, v236 quad_perm:[0,0,0,0] row_mask:0xf bank_mask:0xf
v_mov_b32_dpp v7, v240 quad_perm:[0,0,0,0] row_mask:0xf bank_mask:0xf
v_cvt_pk_bf16_f32 v2, v14, v15
v_lshlrev_b32 v14, 16, v2
v_add_f32_dpp v6, v237, v6 quad_perm:[1,1,1,1] row_mask:0xf bank_mask:0xf
v_add_f32_dpp v7, v241, v7 quad_perm:[1,1,1,1] row_mask:0xf bank_mask:0xf
v_and_b32 v15, 0xffff0000, v2
v_mul_f32 v14, s19, v14
v_add_f32_dpp v6, v238, v6 quad_perm:[2,2,2,2] row_mask:0xf bank_mask:0xf
v_add_f32_dpp v7, v242, v7 quad_perm:[2,2,2,2] row_mask:0xf bank_mask:0xf
v_mul_f32 v15, s19, v15
v_cvt_pk_bf16_f32 v2, v14, v15
v_add_f32_dpp v6, v239, v6 quad_perm:[3,3,3,3] row_mask:0xf bank_mask:0xf
v_add_f32_dpp v7, v243, v7 quad_perm:[3,3,3,3] row_mask:0xf bank_mask:0xf
v_lshlrev_b32 v34, 16, v2
v_and_b32 v35, 0xffff0000, v2
v_max3_f32 v8, v8, v34, v35
v_mfma_f32_16x16x32_bf16 v[236:239], v[112:115], v[232:235], 0
v_mfma_f32_16x16x32_bf16 v[240:243], v[116:119], v[232:235], 0
v_mov_b32_dpp v14, v244 quad_perm:[0,0,0,0] row_mask:0xf bank_mask:0xf
v_mov_b32_dpp v15, v248 quad_perm:[0,0,0,0] row_mask:0xf bank_mask:0xf
v_cvt_pk_bf16_f32 v2, v6, v7
v_lshlrev_b32 v6, 16, v2
v_add_f32_dpp v14, v245, v14 quad_perm:[1,1,1,1] row_mask:0xf bank_mask:0xf
v_add_f32_dpp v15, v249, v15 quad_perm:[1,1,1,1] row_mask:0xf bank_mask:0xf
v_and_b32 v7, 0xffff0000, v2
v_mul_f32 v6, s19, v6
v_add_f32_dpp v14, v246, v14 quad_perm:[2,2,2,2] row_mask:0xf bank_mask:0xf
v_add_f32_dpp v15, v250, v15 quad_perm:[2,2,2,2] row_mask:0xf bank_mask:0xf
v_mul_f32 v7, s19, v7
v_cvt_pk_bf16_f32 v2, v6, v7
v_add_f32_dpp v14, v247, v14 quad_perm:[3,3,3,3] row_mask:0xf bank_mask:0xf
v_add_f32_dpp v15, v251, v15 quad_perm:[3,3,3,3] row_mask:0xf bank_mask:0xf
v_lshlrev_b32 v36, 16, v2
v_and_b32 v37, 0xffff0000, v2
v_max3_f32 v8, v8, v36, v37
v_mfma_f32_16x16x32_bf16 v[244:247], v[120:123], v[232:235], 0
v_mfma_f32_16x16x32_bf16 v[248:251], v[124:127], v[232:235], 0
v_mov_b32_dpp v6, v236 quad_perm:[0,0,0,0] row_mask:0xf bank_mask:0xf
v_mov_b32_dpp v7, v240 quad_perm:[0,0,0,0] row_mask:0xf bank_mask:0xf
v_cvt_pk_bf16_f32 v2, v14, v15
v_lshlrev_b32 v14, 16, v2
v_add_f32_dpp v6, v237, v6 quad_perm:[1,1,1,1] row_mask:0xf bank_mask:0xf
v_add_f32_dpp v7, v241, v7 quad_perm:[1,1,1,1] row_mask:0xf bank_mask:0xf
v_and_b32 v15, 0xffff0000, v2
v_mul_f32 v14, s19, v14
v_add_f32_dpp v6, v238, v6 quad_perm:[2,2,2,2] row_mask:0xf bank_mask:0xf
v_add_f32_dpp v7, v242, v7 quad_perm:[2,2,2,2] row_mask:0xf bank_mask:0xf
v_mul_f32 v15, s19, v15
v_cvt_pk_bf16_f32 v2, v14, v15
v_add_f32_dpp v6, v239, v6 quad_perm:[3,3,3,3] row_mask:0xf bank_mask:0xf
v_add_f32_dpp v7, v243, v7 quad_perm:[3,3,3,3] row_mask:0xf bank_mask:0xf
v_lshlrev_b32 v38, 16, v2
v_and_b32 v39, 0xffff0000, v2
v_max3_f32 v8, v8, v38, v39
v_mfma_f32_16x16x32_bf16 v[236:239], v[128:131], v[232:235], 0
v_mfma_f32_16x16x32_bf16 v[240:243], v[132:135], v[232:235], 0
v_mov_b32_dpp v14, v244 quad_perm:[0,0,0,0] row_mask:0xf bank_mask:0xf
v_mov_b32_dpp v15, v248 quad_perm:[0,0,0,0] row_mask:0xf bank_mask:0xf
v_cvt_pk_bf16_f32 v2, v6, v7
v_lshlrev_b32 v6, 16, v2
v_add_f32_dpp v14, v245, v14 quad_perm:[1,1,1,1] row_mask:0xf bank_mask:0xf
v_add_f32_dpp v15, v249, v15 quad_perm:[1,1,1,1] row_mask:0xf bank_mask:0xf
v_and_b32 v7, 0xffff0000, v2
v_mul_f32 v6, s19, v6
v_add_f32_dpp v14, v246, v14 quad_perm:[2,2,2,2] row_mask:0xf bank_mask:0xf
v_add_f32_dpp v15, v250, v15 quad_perm:[2,2,2,2] row_mask:0xf bank_mask:0xf
v_mul_f32 v7, s19, v7
v_cvt_pk_bf16_f32 v2, v6, v7
v_add_f32_dpp v14, v247, v14 quad_perm:[3,3,3,3] row_mask:0xf bank_mask:0xf
v_add_f32_dpp v15, v251, v15 quad_perm:[3,3,3,3] row_mask:0xf bank_mask:0xf
v_lshlrev_b32 v40, 16, v2
v_and_b32 v41, 0xffff0000, v2
v_max3_f32 v8, v8, v40, v41
v_mfma_f32_16x16x32_bf16 v[244:247], v[136:139], v[232:235], 0
v_mfma_f32_16x16x32_bf16 v[248:251], v[140:143], v[232:235], 0
v_mov_b32_dpp v6, v236 quad_perm:[0,0,0,0] row_mask:0xf bank_mask:0xf
v_mov_b32_dpp v7, v240 quad_perm:[0,0,0,0] row_mask:0xf bank_mask:0xf
v_cvt_pk_bf16_f32 v2, v14, v15
v_lshlrev_b32 v14, 16, v2
v_add_f32_dpp v6, v237, v6 quad_perm:[1,1,1,1] row_mask:0xf bank_mask:0xf
v_add_f32_dpp v7, v241, v7 quad_perm:[1,1,1,1] row_mask:0xf bank_mask:0xf
v_and_b32 v15, 0xffff0000, v2
v_mul_f32 v14, s19, v14
v_add_f32_dpp v6, v238, v6 quad_perm:[2,2,2,2] row_mask:0xf bank_mask:0xf
v_add_f32_dpp v7, v242, v7 quad_perm:[2,2,2,2] row_mask:0xf bank_mask:0xf
v_mul_f32 v15, s19, v15
v_cvt_pk_bf16_f32 v2, v14, v15
v_add_f32_dpp v6, v239, v6 quad_perm:[3,3,3,3] row_mask:0xf bank_mask:0xf
v_add_f32_dpp v7, v243, v7 quad_perm:[3,3,3,3] row_mask:0xf bank_mask:0xf
v_lshlrev_b32 v42, 16, v2
v_and_b32 v43, 0xffff0000, v2
v_max3_f32 v8, v8, v42, v43
v_mfma_f32_16x16x32_bf16 v[236:239], v[144:147], v[232:235], 0
v_mfma_f32_16x16x32_bf16 v[240:243], v[148:151], v[232:235], 0
v_mov_b32_dpp v14, v244 quad_perm:[0,0,0,0] row_mask:0xf bank_mask:0xf
v_mov_b32_dpp v15, v248 quad_perm:[0,0,0,0] row_mask:0xf bank_mask:0xf
v_cvt_pk_bf16_f32 v2, v6, v7
v_lshlrev_b32 v6, 16, v2
v_add_f32_dpp v14, v245, v14 quad_perm:[1,1,1,1] row_mask:0xf bank_mask:0xf
v_add_f32_dpp v15, v249, v15 quad_perm:[1,1,1,1] row_mask:0xf bank_mask:0xf
v_and_b32 v7, 0xffff0000, v2
v_mul_f32 v6, s19, v6
v_add_f32_dpp v14, v246, v14 quad_perm:[2,2,2,2] row_mask:0xf bank_mask:0xf
v_add_f32_dpp v15, v250, v15 quad_perm:[2,2,2,2] row_mask:0xf bank_mask:0xf
v_mul_f32 v7, s19, v7
v_cvt_pk_bf16_f32 v2, v6, v7
v_add_f32_dpp v14, v247, v14 quad_perm:[3,3,3,3] row_mask:0xf bank_mask:0xf
v_add_f32_dpp v15, v251, v15 quad_perm:[3,3,3,3] row_mask:0xf bank_mask:0xf
v_lshlrev_b32 v44, 16, v2
v_and_b32 v45, 0xffff0000, v2
v_max3_f32 v8, v8, v44, v45
v_mfma_f32_16x16x32_bf16 v[244:247], v[152:155], v[232:235], 0
v_mfma_f32_16x16x32_bf16 v[248:251], v[156:159], v[232:235], 0
v_mov_b32_dpp v6, v236 quad_perm:[0,0,0,0] row_mask:0xf bank_mask:0xf
v_mov_b32_dpp v7, v240 quad_perm:[0,0,0,0] row_mask:0xf bank_mask:0xf
v_cvt_pk_bf16_f32 v2, v14, v15
v_lshlrev_b32 v14, 16, v2
v_add_f32_dpp v6, v237, v6 quad_perm:[1,1,1,1] row_mask:0xf bank_mask:0xf
v_add_f32_dpp v7, v241, v7 quad_perm:[1,1,1,1] row_mask:0xf bank_mask:0xf
v_and_b32 v15, 0xffff0000, v2
v_mul_f32 v14, s19, v14
v_add_f32_dpp v6, v238, v6 quad_perm:[2,2,2,2] row_mask:0xf bank_mask:0xf
v_add_f32_dpp v7, v242, v7 quad_perm:[2,2,2,2] row_mask:0xf bank_mask:0xf
v_mul_f32 v15, s19, v15
v_cvt_pk_bf16_f32 v2, v14, v15
v_add_f32_dpp v6, v239, v6 quad_perm:[3,3,3,3] row_mask:0xf bank_mask:0xf
v_add_f32_dpp v7, v243, v7 quad_perm:[3,3,3,3] row_mask:0xf bank_mask:0xf
v_lshlrev_b32 v46, 16, v2
v_and_b32 v47, 0xffff0000, v2
v_max3_f32 v8, v8, v46, v47
v_mfma_f32_16x16x32_bf16 v[236:239], v[160:163], v[232:235], 0
v_mfma_f32_16x16x32_bf16 v[240:243], v[164:167], v[232:235], 0
v_mov_b32_dpp v14, v244 quad_perm:[0,0,0,0] row_mask:0xf bank_mask:0xf
v_mov_b32_dpp v15, v248 quad_perm:[0,0,0,0] row_mask:0xf bank_mask:0xf
v_cvt_pk_bf16_f32 v2, v6, v7
v_lshlrev_b32 v6, 16, v2
v_add_f32_dpp v14, v245, v14 quad_perm:[1,1,1,1] row_mask:0xf bank_mask:0xf
v_add_f32_dpp v15, v249, v15 quad_perm:[1,1,1,1] row_mask:0xf bank_mask:0xf
v_and_b32 v7, 0xffff0000, v2
v_mul_f32 v6, s19, v6
v_add_f32_dpp v14, v246, v14 quad_perm:[2,2,2,2] row_mask:0xf bank_mask:0xf
v_add_f32_dpp v15, v250, v15 quad_perm:[2,2,2,2] row_mask:0xf bank_mask:0xf
v_mul_f32 v7, s19, v7
v_cvt_pk_bf16_f32 v2, v6, v7
v_add_f32_dpp v14, v247, v14 quad_perm:[3,3,3,3] row_mask:0xf bank_mask:0xf
v_add_f32_dpp v15, v251, v15 quad_perm:[3,3,3,3] row_mask:0xf bank_mask:0xf
v_lshlrev_b32 v48, 16, v2
s_cmp_gt_u32 s27, 32
s_cselect_b32 s18, s78, s79
v_min_f32 v48, s18, v48
v_and_b32 v49, 0xffff0000, v2
s_cmp_gt_u32 s27, 33
s_cselect_b32 s18, s78, s79
v_min_f32 v49, s18, v49
v_max3_f32 v8, v8, v48, v49
v_mfma_f32_16x16x32_bf16 v[244:247], v[168:171], v[232:235], 0
v_mov_b32_dpp v6, v236 quad_perm:[0,0,0,0] row_mask:0xf bank_mask:0xf
v_mov_b32_dpp v7, v240 quad_perm:[0,0,0,0] row_mask:0xf bank_mask:0xf
v_cvt_pk_bf16_f32 v2, v14, v15
v_lshlrev_b32 v14, 16, v2
v_add_f32_dpp v6, v237, v6 quad_perm:[1,1,1,1] row_mask:0xf bank_mask:0xf
v_add_f32_dpp v7, v241, v7 quad_perm:[1,1,1,1] row_mask:0xf bank_mask:0xf
v_and_b32 v15, 0xffff0000, v2
v_mul_f32 v14, s19, v14
v_add_f32_dpp v6, v238, v6 quad_perm:[2,2,2,2] row_mask:0xf bank_mask:0xf
v_add_f32_dpp v7, v242, v7 quad_perm:[2,2,2,2] row_mask:0xf bank_mask:0xf
v_mul_f32 v15, s19, v15
v_cvt_pk_bf16_f32 v2, v14, v15
v_add_f32_dpp v6, v239, v6 quad_perm:[3,3,3,3] row_mask:0xf bank_mask:0xf
v_add_f32_dpp v7, v243, v7 quad_perm:[3,3,3,3] row_mask:0xf bank_mask:0xf
v_lshlrev_b32 v50, 16, v2
s_cmp_gt_u32 s27, 34
s_cselect_b32 s18, s78, s79
v_min_f32 v50, s18, v50
v_and_b32 v51, 0xffff0000, v2
s_cmp_gt_u32 s27, 35
s_cselect_b32 s18, s78, s79
v_min_f32 v51, s18, v51
v_max3_f32 v8, v8, v50, v51
v_mov_b32_dpp v14, v244 quad_perm:[0,0,0,0] row_mask:0xf bank_mask:0xf
v_cvt_pk_bf16_f32 v2, v6, v7
v_lshlrev_b32 v6, 16, v2
v_add_f32_dpp v14, v245, v14 quad_perm:[1,1,1,1] row_mask:0xf bank_mask:0xf
v_and_b32 v7, 0xffff0000, v2
v_mul_f32 v6, s19, v6
v_add_f32_dpp v14, v246, v14 quad_perm:[2,2,2,2] row_mask:0xf bank_mask:0xf
v_mul_f32 v7, s19, v7
v_cvt_pk_bf16_f32 v2, v6, v7
v_add_f32_dpp v14, v247, v14 quad_perm:[3,3,3,3] row_mask:0xf bank_mask:0xf
v_lshlrev_b32 v52, 16, v2
s_cmp_gt_u32 s27, 36
s_cselect_b32 s18, s78, s79
v_min_f32 v52, s18, v52
v_and_b32 v53, 0xffff0000, v2
s_cmp_gt_u32 s27, 37
s_cselect_b32 s18, s78, s79
v_min_f32 v53, s18, v53
v_max3_f32 v8, v8, v52, v53
v_cvt_pk_bf16_f32 v2, v14, v14
v_lshlrev_b32 v14, 16, v2
v_mul_f32 v14, s19, v14
v_cvt_pk_bf16_f32 v2, v14, v14
v_lshlrev_b32 v54, 16, v2
s_cmp_gt_u32 s27, 38
s_cselect_b32 s18, s78, s79
v_min_f32 v54, s18, v54
v_max_f32 v8, v8, v54
v_mov_b32 v6, v8
s_nop 1
v_permlane16_swap_b32 v8, v6
v_max_f32 v8, v8, v6
v_mov_b32 v6, v8
s_nop 1
v_permlane32_swap_b32 v8, v6
v_max_f32 v8, v8, v6
v_bfe_u32 v6, v1, 3, 1
v_lshlrev_b32 v6, 5, v6
s_lshl_b32 s22, s62, 2
v_add_u32 v7, s22, v6
ds_write_b32 v7, v8 offset:512
s_waitcnt lgkmcnt(0)
s_barrier
ds_read_b128 v[236:239], v6 offset:512
ds_read_b128 v[240:243], v6 offset:528
s_waitcnt lgkmcnt(0)
v_max3_f32 v8, v236, v237, v238
v_max3_f32 v14, v239, v240, v241
v_max3_f32 v8, v8, v242, v243
v_max_f32 v8, v8, v14
v_mul_f32 v14, s20, v8
v_fma_f32 v16, v16, s20, -v14
v_fma_f32 v17, v17, s20, -v14
v_fma_f32 v18, v18, s20, -v14
v_fma_f32 v19, v19, s20, -v14
v_fma_f32 v20, v20, s20, -v14
v_fma_f32 v21, v21, s20, -v14
v_fma_f32 v22, v22, s20, -v14
v_fma_f32 v23, v23, s20, -v14
v_fma_f32 v24, v24, s20, -v14
v_fma_f32 v25, v25, s20, -v14
v_fma_f32 v26, v26, s20, -v14
v_fma_f32 v27, v27, s20, -v14
v_fma_f32 v28, v28, s20, -v14
v_fma_f32 v29, v29, s20, -v14
v_fma_f32 v30, v30, s20, -v14
v_fma_f32 v31, v31, s20, -v14
v_fma_f32 v32, v32, s20, -v14
v_fma_f32 v33, v33, s20, -v14
v_fma_f32 v34, v34, s20, -v14
v_fma_f32 v35, v35, s20, -v14
v_fma_f32 v36, v36, s20, -v14
v_fma_f32 v37, v37, s20, -v14
v_fma_f32 v38, v38, s20, -v14
v_fma_f32 v39, v39, s20, -v14
v_fma_f32 v40, v40, s20, -v14
v_fma_f32 v41, v41, s20, -v14
v_fma_f32 v42, v42, s20, -v14
v_fma_f32 v43, v43, s20, -v14
v_fma_f32 v44, v44, s20, -v14
v_fma_f32 v45, v45, s20, -v14
v_fma_f32 v46, v46, s20, -v14
v_fma_f32 v47, v47, s20, -v14
v_fma_f32 v48, v48, s20, -v14
v_fma_f32 v49, v49, s20, -v14
v_fma_f32 v50, v50, s20, -v14
v_fma_f32 v51, v51, s20, -v14
v_fma_f32 v52, v52, s20, -v14
v_fma_f32 v53, v53, s20, -v14
v_fma_f32 v54, v54, s20, -v14
v_exp_f32 v16, v16
v_exp_f32 v17, v17
v_add_f32 v9, v9, v16
v_cvt_pk_bf16_f32 v16, v16, v16
v_exp_f32 v18, v18
v_add_f32 v9, v9, v17
v_cvt_pk_bf16_f32 v17, v17, v17
v_exp_f32 v19, v19
v_add_f32 v9, v9, v18
v_cvt_pk_bf16_f32 v18, v18, v18
v_exp_f32 v20, v20
v_add_f32 v9, v9, v19
v_cvt_pk_bf16_f32 v19, v19, v19
v_exp_f32 v21, v21
v_add_f32 v9, v9, v20
v_cvt_pk_bf16_f32 v20, v20, v20
v_exp_f32 v22, v22
v_add_f32 v9, v9, v21
v_cvt_pk_bf16_f32 v21, v21, v21
v_exp_f32 v23, v23
v_add_f32 v9, v9, v22
v_cvt_pk_bf16_f32 v22, v22, v22
v_exp_f32 v24, v24
v_add_f32 v9, v9, v23
v_cvt_pk_bf16_f32 v23, v23, v23
v_exp_f32 v25, v25
v_add_f32 v9, v9, v24
v_cvt_pk_bf16_f32 v24, v24, v24
v_exp_f32 v26, v26
v_add_f32 v9, v9, v25
v_cvt_pk_bf16_f32 v25, v25, v25
v_exp_f32 v27, v27
v_add_f32 v9, v9, v26
v_cvt_pk_bf16_f32 v26, v26, v26
v_exp_f32 v28, v28
v_add_f32 v9, v9, v27
v_cvt_pk_bf16_f32 v27, v27, v27
v_exp_f32 v29, v29
v_add_f32 v9, v9, v28
v_cvt_pk_bf16_f32 v28, v28, v28
v_exp_f32 v30, v30
v_add_f32 v9, v9, v29
v_cvt_pk_bf16_f32 v29, v29, v29
v_exp_f32 v31, v31
v_add_f32 v9, v9, v30
v_cvt_pk_bf16_f32 v30, v30, v30
v_exp_f32 v32, v32
v_add_f32 v9, v9, v31
v_cvt_pk_bf16_f32 v31, v31, v31
v_exp_f32 v33, v33
v_add_f32 v9, v9, v32
v_cvt_pk_bf16_f32 v32, v32, v32
v_exp_f32 v34, v34
v_add_f32 v9, v9, v33
v_cvt_pk_bf16_f32 v33, v33, v33
v_exp_f32 v35, v35
v_add_f32 v9, v9, v34
v_cvt_pk_bf16_f32 v34, v34, v34
v_exp_f32 v36, v36
v_add_f32 v9, v9, v35
v_cvt_pk_bf16_f32 v35, v35, v35
v_exp_f32 v37, v37
v_add_f32 v9, v9, v36
v_cvt_pk_bf16_f32 v36, v36, v36
v_exp_f32 v38, v38
v_add_f32 v9, v9, v37
v_cvt_pk_bf16_f32 v37, v37, v37
v_exp_f32 v39, v39
v_add_f32 v9, v9, v38
v_cvt_pk_bf16_f32 v38, v38, v38
v_exp_f32 v40, v40
v_add_f32 v9, v9, v39
v_cvt_pk_bf16_f32 v39, v39, v39
v_exp_f32 v41, v41
v_add_f32 v9, v9, v40
v_cvt_pk_bf16_f32 v40, v40, v40
v_exp_f32 v42, v42
v_add_f32 v9, v9, v41
v_cvt_pk_bf16_f32 v41, v41, v41
v_exp_f32 v43, v43
v_add_f32 v9, v9, v42
v_cvt_pk_bf16_f32 v42, v42, v42
v_exp_f32 v44, v44
v_add_f32 v9, v9, v43
v_cvt_pk_bf16_f32 v43, v43, v43
v_exp_f32 v45, v45
v_add_f32 v9, v9, v44
v_cvt_pk_bf16_f32 v44, v44, v44
v_exp_f32 v46, v46
v_add_f32 v9, v9, v45
v_cvt_pk_bf16_f32 v45, v45, v45
v_exp_f32 v47, v47
v_add_f32 v9, v9, v46
v_cvt_pk_bf16_f32 v46, v46, v46
v_exp_f32 v48, v48
v_add_f32 v9, v9, v47
v_cvt_pk_bf16_f32 v47, v47, v47
v_exp_f32 v49, v49
v_add_f32 v9, v9, v48
v_cvt_pk_bf16_f32 v48, v48, v48
v_exp_f32 v50, v50
v_add_f32 v9, v9, v49
v_cvt_pk_bf16_f32 v49, v49, v49
v_exp_f32 v51, v51
v_add_f32 v9, v9, v50
v_cvt_pk_bf16_f32 v50, v50, v50
v_exp_f32 v52, v52
v_add_f32 v9, v9, v51
v_cvt_pk_bf16_f32 v51, v51, v51
v_exp_f32 v53, v53
v_add_f32 v9, v9, v52
v_cvt_pk_bf16_f32 v52, v52, v52
v_exp_f32 v54, v54
v_add_f32 v9, v9, v53
v_cvt_pk_bf16_f32 v53, v53, v53
v_add_f32 v9, v9, v54
v_cvt_pk_bf16_f32 v54, v54, v54
v_mov_b32 v15, v9
s_nop 1
v_permlane16_swap_b32 v9, v15
v_add_f32 v9, v9, v15
v_mov_b32 v15, v9
s_nop 1
v_permlane32_swap_b32 v9, v15
v_add_f32 v9, v9, v15
ds_write_b32 v7, v9 offset:576
v_lshrrev_b32 v2, 5, v1
v_lshlrev_b32 v2, 9, v2
v_and_b32 v4, 15, v1
v_lshl_add_u32 v2, v4, 5, v2
v_bfe_u32 v4, v1, 4, 1
v_lshl_add_u32 v2, v4, 4, v2
s_lshl_b32 s22, s62, 10
v_add_u32 v2, s22, v2
s_lshl_b32 s22, s62, 9
v_lshlrev_b32 v4, 3, v1
v_add_u32 v4, s22, v4
s_lshl_b32 s80, s63, 1
s_add_u32 s80, s80, s62
s_lshl_b32 s80, s80, 3
s_add_u32 s80, s80, s64
s_lshl_b32 s80, s80, 10
s_add_u32 s80, s80, 786432
v_and_b32 v236, v16, v10
v_and_b32 v237, v16, v11
v_and_b32 v238, v16, v12
v_and_b32 v239, v16, v13
s_add_u32 s17, s16, 19456
buffer_load_dwordx4 v[72:75], v3, s[12:15], s17 offen nt
v_and_b32 v240, v17, v10
v_and_b32 v241, v17, v11
v_and_b32 v242, v17, v12
v_and_b32 v243, v17, v13
s_waitcnt vmcnt(19)
v_mfma_f32_16x16x32_bf16 v[252:255], v[236:239], v[172:175], v[252:255]
s_add_u32 s17, s16, 20480
buffer_load_dwordx4 v[76:79], v3, s[12:15], s17 offen nt
v_and_b32 v236, v18, v10
v_and_b32 v237, v18, v11
v_and_b32 v238, v18, v12
v_and_b32 v239, v18, v13
s_waitcnt vmcnt(19)
v_mfma_f32_16x16x32_bf16 v[252:255], v[240:243], v[176:179], v[252:255]
s_add_u32 s17, s16, 21504
buffer_load_dwordx4 v[80:83], v3, s[12:15], s17 offen nt
v_and_b32 v240, v19, v10
v_and_b32 v241, v19, v11
v_and_b32 v242, v19, v12
v_and_b32 v243, v19, v13
s_waitcnt vmcnt(19)
v_mfma_f32_16x16x32_bf16 v[252:255], v[236:239], v[180:183], v[252:255]
s_add_u32 s17, s16, 22528
buffer_load_dwordx4 v[84:87], v3, s[12:15], s17 offen nt
v_and_b32 v236, v20, v10
v_and_b32 v237, v20, v11
v_and_b32 v238, v20, v12
v_and_b32 v239, v20, v13
s_waitcnt vmcnt(19)
v_mfma_f32_16x16x32_bf16 v[252:255], v[240:243], v[184:187], v[252:255]
s_add_u32 s17, s16, 23552
buffer_load_dwordx4 v[88:91], v3, s[12:15], s17 offen nt
v_and_b32 v240, v21, v10
v_and_b32 v241, v21, v11
v_and_b32 v242, v21, v12
v_and_b32 v243, v21, v13
s_waitcnt vmcnt(19)
v_mfma_f32_16x16x32_bf16 v[252:255], v[236:239], v[188:191], v[252:255]
s_waitcnt lgkmcnt(0)
s_barrier
s_cmp_lg_u32 s62, 0
s_cbranch_scc1 L_s_noml
ds_read_b128 v[244:247], v6 offset:576
ds_read_b128 v[248:251], v6 offset:592
s_lshl_b32 s22, s63, 8
s_lshl_b32 s23, s64, 4
s_add_u32 s22, s22, s23
s_add_u32 s22, s22, 65536
v_lshlrev_b32 v14, 2, v6
v_and_b32 v15, 0x37, v1
v_cmp_eq_u32 vcc, 0, v15
v_mov_b32 v15, 2147483648
s_nop 0
v_cndmask_b32 v14, v15, v14, vcc
s_waitcnt lgkmcnt(0)
v_add_f32 v244, v244, v245
v_add_f32 v246, v246, v247
v_add_f32 v248, v248, v249
v_add_f32 v250, v250, v251
v_add_f32 v244, v244, v246
v_add_f32 v248, v248, v250
v_add_f32 v246, v244, v248
v_mov_b32 v244, v8
v_mov_b32 v245, s66
v_mov_b32 v247, s66
buffer_store_dwordx4 v[244:247], v14, s[4:7], s22 offen sc1
L_s_noml:
s_add_u32 s17, s16, 24576
buffer_load_dwordx4 v[92:95], v3, s[12:15], s17 offen nt
v_and_b32 v236, v22, v10
v_and_b32 v237, v22, v11
v_and_b32 v238, v22, v12
v_and_b32 v239, v22, v13
s_waitcnt vmcnt(19)
v_mfma_f32_16x16x32_bf16 v[252:255], v[240:243], v[192:195], v[252:255]
s_add_u32 s17, s16, 25600
buffer_load_dwordx4 v[96:99], v3, s[12:15], s17 offen nt
v_and_b32 v240, v23, v10
v_and_b32 v241, v23, v11
v_and_b32 v242, v23, v12
v_and_b32 v243, v23, v13
s_waitcnt vmcnt(19)
v_mfma_f32_16x16x32_bf16 v[252:255], v[236:239], v[196:199], v[252:255]
s_add_u32 s17, s25, 26624
buffer_load_dwordx4 v[100:103], v3, s[12:15], s17 offen nt
v_and_b32 v236, v24, v10
v_and_b32 v237, v24, v11
v_and_b32 v238, v24, v12
v_and_b32 v239, v24, v13
s_waitcnt vmcnt(19)
v_mfma_f32_16x16x32_bf16 v[252:255], v[240:243], v[200:203], v[252:255]
s_add_u32 s17, s25, 27648
buffer_load_dwordx4 v[104:107], v3, s[12:15], s17 offen nt
v_and_b32 v240, v25, v10
v_and_b32 v241, v25, v11
v_and_b32 v242, v25, v12
v_and_b32 v243, v25, v13
s_waitcnt vmcnt(19)
v_mfma_f32_16x16x32_bf16 v[252:255], v[236:239], v[204:207], v[252:255]
s_add_u32 s17, s25, 28672
buffer_load_dwordx4 v[108:111], v3, s[12:15], s17 offen nt
v_and_b32 v236, v26, v10
v_and_b32 v237, v26, v11
v_and_b32 v238, v26, v12
v_and_b32 v239, v26, v13
s_waitcnt vmcnt(19)
v_mfma_f32_16x16x32_bf16 v[252:255], v[240:243], v[208:211], v[252:255]
s_add_u32 s17, s25, 29696
buffer_load_dwordx4 v[112:115], v3, s[12:15], s17 offen nt
v_and_b32 v240, v27, v10
v_and_b32 v241, v27, v11
v_and_b32 v242, v27, v12
v_and_b32 v243, v27, v13
s_waitcnt vmcnt(19)
v_mfma_f32_16x16x32_bf16 v[252:255], v[236:239], v[212:215], v[252:255]
s_add_u32 s17, s25, 30720
buffer_load_dwordx4 v[116:119], v3, s[12:15], s17 offen nt
v_and_b32 v236, v28, v10
v_and_b32 v237, v28, v11
v_and_b32 v238, v28, v12
v_and_b32 v239, v28, v13
s_waitcnt vmcnt(19)
v_mfma_f32_16x16x32_bf16 v[252:255], v[240:243], v[216:219], v[252:255]
s_add_u32 s17, s25, 31744
buffer_load_dwordx4 v[120:123], v3, s[12:15], s17 offen nt
v_and_b32 v240, v29, v10
v_and_b32 v241, v29, v11
v_and_b32 v242, v29, v12
v_and_b32 v243, v29, v13
s_waitcnt vmcnt(19)
v_mfma_f32_16x16x32_bf16 v[252:255], v[236:239], v[220:223], v[252:255]
s_cmp_gt_u32 s27, 32
s_cselect_b32 s17, 0, 2147483648
v_or_b32 v5, s17, v3
s_add_u32 s17, s25, 32768
buffer_load_dwordx4 v[124:127], v5, s[12:15], s17 offen nt
v_and_b32 v236, v30, v10
v_and_b32 v237, v30, v11
v_and_b32 v238, v30, v12
v_and_b32 v239, v30, v13
s_waitcnt vmcnt(19)
v_mfma_f32_16x16x32_bf16 v[252:255], v[240:243], v[224:227], v[252:255]
s_cmp_gt_u32 s27, 33
s_cselect_b32 s17, 0, 2147483648
v_or_b32 v5, s17, v3
s_add_u32 s17, s25, 33792
buffer_load_dwordx4 v[128:131], v5, s[12:15], s17 offen nt
v_and_b32 v240, v31, v10
v_and_b32 v241, v31, v11
v_and_b32 v242, v31, v12
v_and_b32 v243, v31, v13
s_waitcnt vmcnt(19)
v_mfma_f32_16x16x32_bf16 v[252:255], v[236:239], v[228:231], v[252:255]
s_cmp_gt_u32 s27, 34
s_cselect_b32 s17, 0, 2147483648
v_or_b32 v5, s17, v3
s_add_u32 s17, s25, 34816
buffer_load_dwordx4 v[132:135], v5, s[12:15], s17 offen nt
v_and_b32 v236, v32, v10
v_and_b32 v237, v32, v11
v_and_b32 v238, v32, v12
v_and_b32 v239, v32, v13
s_waitcnt vmcnt(19)
v_mfma_f32_16x16x32_bf16 v[252:255], v[240:243], v[56:59], v[252:255]
s_cmp_gt_u32 s27, 35
s_cselect_b32 s17, 0, 2147483648
v_or_b32 v5, s17, v3
s_add_u32 s17, s25, 35840
buffer_load_dwordx4 v[136:139], v5, s[12:15], s17 offen nt
v_and_b32 v240, v33, v10
v_and_b32 v241, v33, v11
v_and_b32 v242, v33, v12
v_and_b32 v243, v33, v13
s_waitcnt vmcnt(19)
v_mfma_f32_16x16x32_bf16 v[252:255], v[236:239], v[60:63], v[252:255]
s_cmp_gt_u32 s27, 36
s_cselect_b32 s17, 0, 2147483648
v_or_b32 v5, s17, v3
s_add_u32 s17, s25, 36864
buffer_load_dwordx4 v[140:143], v5, s[12:15], s17 offen nt
v_and_b32 v236, v34, v10
v_and_b32 v237, v34, v11
v_and_b32 v238, v34, v12
v_and_b32 v239, v34, v13
s_waitcnt vmcnt(19)
v_mfma_f32_16x16x32_bf16 v[252:255], v[240:243], v[64:67], v[252:255]
s_cmp_gt_u32 s27, 37
s_cselect_b32 s17, 0, 2147483648
v_or_b32 v5, s17, v3
s_add_u32 s17, s25, 37888
buffer_load_dwordx4 v[144:147], v5, s[12:15], s17 offen nt
v_and_b32 v240, v35, v10
v_and_b32 v241, v35, v11
v_and_b32 v242, v35, v12
v_and_b32 v243, v35, v13
s_waitcnt vmcnt(19)
v_mfma_f32_16x16x32_bf16 v[252:255], v[236:239], v[68:71], v[252:255]
s_cmp_gt_u32 s27, 38
s_cselect_b32 s17, 0, 2147483648
v_or_b32 v5, s17, v3
s_add_u32 s17, s25, 38912
buffer_load_dwordx4 v[148:151], v5, s[12:15], s17 offen nt
v_and_b32 v236, v36, v10
v_and_b32 v237, v36, v11
v_and_b32 v238, v36, v12
v_and_b32 v239, v36, v13
s_waitcnt vmcnt(19)
v_mfma_f32_16x16x32_bf16 v[252:255], v[240:243], v[72:75], v[252:255]
v_and_b32 v240, v37, v10
v_and_b32 v241, v37, v11
v_and_b32 v242, v37, v12
v_and_b32 v243, v37, v13
s_waitcnt vmcnt(18)
v_mfma_f32_16x16x32_bf16 v[252:255], v[236:239], v[76:79], v[252:255]
v_and_b32 v236, v38, v10
v_and_b32 v237, v38, v11
v_and_b32 v238, v38, v12
v_and_b32 v239, v38, v13
s_waitcnt vmcnt(17)
v_mfma_f32_16x16x32_bf16 v[252:255], v[240:243], v[80:83], v[252:255]
v_and_b32 v240, v39, v10
v_and_b32 v241, v39, v11
v_and_b32 v242, v39, v12
v_and_b32 v243, v39, v13
s_waitcnt vmcnt(16)
v_mfma_f32_16x16x32_bf16 v[252:255], v[236:239], v[84:87], v[252:255]
v_and_b32 v236, v40, v10
v_and_b32 v237, v40, v11
v_and_b32 v238, v40, v12
v_and_b32 v239, v40, v13
s_waitcnt vmcnt(15)
v_mfma_f32_16x16x32_bf16 v[252:255], v[240:243], v[88:91], v[252:255]
v_and_b32 v240, v41, v10
v_and_b32 v241, v41, v11
v_and_b32 v242, v41, v12
v_and_b32 v243, v41, v13
s_waitcnt vmcnt(14)
v_mfma_f32_16x16x32_bf16 v[252:255], v[236:239], v[92:95], v[252:255]
v_and_b32 v236, v42, v10
v_and_b32 v237, v42, v11
v_and_b32 v238, v42, v12
v_and_b32 v239, v42, v13
s_waitcnt vmcnt(13)
v_mfma_f32_16x16x32_bf16 v[252:255], v[240:243], v[96:99], v[252:255]
v_and_b32 v240, v43, v10
v_and_b32 v241, v43, v11
v_and_b32 v242, v43, v12
v_and_b32 v243, v43, v13
s_waitcnt vmcnt(12)
v_mfma_f32_16x16x32_bf16 v[252:255], v[236:239], v[100:103], v[252:255]
v_and_b32 v236, v44, v10
v_and_b32 v237, v44, v11
v_and_b32 v238, v44, v12
v_and_b32 v239, v44, v13
s_waitcnt vmcnt(11)
v_mfma_f32_16x16x32_bf16 v[252:255], v[240:243], v[104:107], v[252:255]
v_and_b32 v240, v45, v10
v_and_b32 v241, v45, v11
v_and_b32 v242, v45, v12
v_and_b32 v243, v45, v13
s_waitcnt vmcnt(10)
v_mfma_f32_16x16x32_bf16 v[252:255], v[236:239], v[108:111], v[252:255]
v_and_b32 v236, v46, v10
v_and_b32 v237, v46, v11
v_and_b32 v238, v46, v12
v_and_b32 v239, v46, v13
s_waitcnt vmcnt(9)
v_mfma_f32_16x16x32_bf16 v[252:255], v[240:243], v[112:115], v[252:255]
v_and_b32 v240, v47, v10
v_and_b32 v241, v47, v11
v_and_b32 v242, v47, v12
v_and_b32 v243, v47, v13
s_waitcnt vmcnt(8)
v_mfma_f32_16x16x32_bf16 v[252:255], v[236:239], v[116:119], v[252:255]
v_and_b32 v236, v48, v10
v_and_b32 v237, v48, v11
v_and_b32 v238, v48, v12
v_and_b32 v239, v48, v13
s_waitcnt vmcnt(7)
v_mfma_f32_16x16x32_bf16 v[252:255], v[240:243], v[120:123], v[252:255]
v_and_b32 v240, v49, v10
v_and_b32 v241, v49, v11
v_and_b32 v242, v49, v12
v_and_b32 v243, v49, v13
s_waitcnt vmcnt(6)
v_mfma_f32_16x16x32_bf16 v[252:255], v[236:239], v[124:127], v[252:255]
v_and_b32 v236, v50, v10
v_and_b32 v237, v50, v11
v_and_b32 v238, v50, v12
v_and_b32 v239, v50, v13
s_waitcnt vmcnt(5)
v_mfma_f32_16x16x32_bf16 v[252:255], v[240:243], v[128:131], v[252:255]
v_and_b32 v240, v51, v10
v_and_b32 v241, v51, v11
v_and_b32 v242, v51, v12
v_and_b32 v243, v51, v13
s_waitcnt vmcnt(4)
v_mfma_f32_16x16x32_bf16 v[252:255], v[236:239], v[132:135], v[252:255]
v_and_b32 v236, v52, v10
v_and_b32 v237, v52, v11
v_and_b32 v238, v52, v12
v_and_b32 v239, v52, v13
s_waitcnt vmcnt(3)
v_mfma_f32_16x16x32_bf16 v[252:255], v[240:243], v[136:139], v[252:255]
v_and_b32 v240, v53, v10
v_and_b32 v241, v53, v11
v_and_b32 v242, v53, v12
v_and_b32 v243, v53, v13
s_waitcnt vmcnt(2)
v_mfma_f32_16x16x32_bf16 v[252:255], v[236:239], v[140:143], v[252:255]
v_and_b32 v236, v54, v10
v_and_b32 v237, v54, v11
v_and_b32 v238, v54, v12
v_and_b32 v239, v54, v13
s_waitcnt vmcnt(1)
v_mfma_f32_16x16x32_bf16 v[252:255], v[240:243], v[144:147], v[252:255]
v_mov_b32 v245, s66
v_mov_b32 v247, s66
s_waitcnt vmcnt(0)
v_mfma_f32_16x16x32_bf16 v[252:255], v[236:239], v[148:151], v[252:255]
s_nop 7
ds_write_b128 v2, v[252:255] offset:1024
s_waitcnt lgkmcnt(0)
s_barrier
s_cmp_gt_u32 s62, 1
s_cbranch_scc1 L_end
ds_read_b64 v[16:17], v4 offset:1024
ds_read_b64 v[18:19], v4 offset:2048
ds_read_b64 v[20:21], v4 offset:3072
ds_read_b64 v[22:23], v4 offset:4096
ds_read_b64 v[24:25], v4 offset:5120
ds_read_b64 v[26:27], v4 offset:6144
ds_read_b64 v[28:29], v4 offset:7168
ds_read_b64 v[30:31], v4 offset:8192
s_waitcnt lgkmcnt(6)
v_add_f32 v16, v16, v18
v_add_f32 v17, v17, v19
s_waitcnt lgkmcnt(4)
v_add_f32 v20, v20, v22
v_add_f32 v21, v21, v23
s_waitcnt lgkmcnt(2)
v_add_f32 v24, v24, v26
v_add_f32 v25, v25, v27
s_waitcnt lgkmcnt(0)
v_add_f32 v28, v28, v30
v_add_f32 v29, v29, v31
v_add_f32 v16, v16, v20
v_add_f32 v17, v17, v21
v_add_f32 v24, v24, v28
v_add_f32 v25, v25, v29
v_add_f32 v244, v16, v24
v_add_f32 v246, v17, v25
buffer_store_dwordx4 v[244:247], v3, s[4:7], s80 offen sc1
s_endpgm
L_tail:
v_lshrrev_b32 v16, 3, v1
v_bfe_u32 v17, v1, 1, 2
v_lshrrev_b32 v18, 4, v1
v_sub_u32 v17, v17, v18
v_and_b32 v17, 3, v17
v_lshlrev_b32 v17, 5, v17
v_and_b32 v18, 1, v1
v_lshl_add_u32 v17, v18, 4, v17
v_lshl_add_u32 v3, v16, 13, v17
v_mul_u32_u24 v4, 1152, v16
v_add_u32 v4, v4, v17
s_waitcnt lgkmcnt(0)
s_mov_b32 s8, s38
s_mov_b32 s9, s39
s_mov_b32 s10, 4718592
s_mov_b32 s11, 0x20000
s_and_b32 s17, s62, 1
s_lshr_b32 s19, s62, 1
s_lshl_b32 s18, s63, 8
s_lshl_b32 s20, s17, 7
s_add_u32 s18, s18, s20
s_lshl_b32 s20, s19, 16
s_add_u32 s18, s18, s20
s_mul_i32 s17, s17, 16
s_add_u32 s19, s19, s17
s_lshl_b32 s19, s19, 10
s_add_u32 m0, s19, 0
s_add_u32 s17, s18, 0
buffer_load_dwordx4 v3, s[8:11], s17 offen nt lds
s_add_u32 m0, s19, 4096
s_add_u32 s17, s18, 262144
buffer_load_dwordx4 v3, s[8:11], s17 offen nt lds
s_add_u32 m0, s19, 8192
s_add_u32 s17, s18, 524288
buffer_load_dwordx4 v3, s[8:11], s17 offen nt lds
s_add_u32 m0, s19, 12288
s_add_u32 s17, s18, 786432
buffer_load_dwordx4 v3, s[8:11], s17 offen nt lds
s_cmp_lg_u32 s62, 7
s_cbranch_scc1 L_3
s_getpc_b64 s[4:5]
L_pc_4:
s_sub_u32 s4, s4, L_pc_4-adaLN_cond__gqa_block_cached__dense_activation_squared_relu__decode_kernel
s_subb_u32 s5, s5, 0
s_mov_b32 s6, L_code_end-adaLN_cond__gqa_block_cached__dense_activation_squared_relu__decode_kernel
s_mov_b32 s7, 0x20000
s_lshl_b32 s3, s63, 10
v_lshlrev_b32 v16, 4, v1
buffer_load_dwordx4 v[60:63], v16, s[4:7], s3 offen
L_3:
s_load_dword s65, s[60:61], 0
s_mov_b32 s4, s60
s_mov_b32 s5, s61
s_mov_b32 s6, 4194304
s_mov_b32 s7, 0x20000
v_lshlrev_b32 v16, 2, v0
v_cmp_gt_u32 vcc, 288, v0
s_nop 0
s_mov_b64 s[28:29], vcc
v_mov_b32 v17, 2147483648
v_cndmask_b32 v16, v17, v16, s[28:29]
s_mov_b32 s12, s32
s_mov_b32 s13, s33
s_mov_b32 s14, 2304
s_mov_b32 s15, 0x20000
buffer_load_dword v32, v16, s[12:15], 0 offen
buffer_load_dword v33, v16, s[12:15], 0 offen offset:1152
v_bfe_u32 v18, v1, 4, 1
v_mul_u32_u24 v18, 1152, v18
s_add_u32 s16, s63, 2
s_lshr_b32 s16, s16, 2
s_sub_u32 s96, s63, s16
s_and_b32 s16, s63, 3
s_cmp_eq_u32 s16, 1
s_cselect_b32 s96, 31, s96
s_lshl_b32 s88, s96, 13
s_lshl_b32 s89, s62, 10
s_add_u32 s21, s88, s89
s_cmp_lt_u32 s96, 18
s_cselect_b32 s21, s21, 2147483648
s_cmp_lt_u32 s62, 4
s_cselect_b32 s96, 31, s96
v_and_b32 v19, 3, v1
v_lshrrev_b32 v25, 5, v1
v_lshl_add_u32 v19, v19, 1, v25
s_lshl_b32 s16, s96, 5
s_and_b32 s17, s62, 3
s_lshl_b32 s17, s17, 3
s_add_u32 s16, s16, s17
v_add_u32 v19, s16, v19
v_lshlrev_b32 v25, 1, v19
v_add_u32 v13, v25, v18
buffer_load_ushort v232, v13, s[12:15], 0 offen
s_mov_b32 s12, s50
s_mov_b32 s13, s51
s_mov_b32 s14, 1152
s_mov_b32 s15, 0x20000
buffer_load_ushort v233, v25, s[12:15], 0 offen
s_mov_b32 s12, s46
s_mov_b32 s13, s47
s_mov_b32 s14, 9216
s_mov_b32 s15, 0x20000
s_mul_i32 s16, s63, 288
s_lshl_b32 s17, s62, 5
s_add_u32 s17, s17, s16
v_and_b32 v25, 15, v1
v_lshlrev_b32 v25, 1, v25
buffer_load_ushort v252, v25, s[12:15], s17 offen
buffer_load_ushort v234, v25, s[12:15], s16 offen offset:256
s_mov_b32 s8, s38
s_mov_b32 s9, s39
s_mov_b32 s10, 4718592
s_mov_b32 s11, 0x20000
s_and_b32 s17, s62, 1
s_lshr_b32 s19, s62, 1
s_lshl_b32 s18, s63, 8
s_lshl_b32 s20, s17, 7
s_add_u32 s18, s18, s20
s_lshl_b32 s20, s19, 16
s_add_u32 s18, s18, s20
s_mul_i32 s17, s17, 16
s_add_u32 s19, s19, s17
s_lshl_b32 s19, s19, 10
s_add_u32 m0, s19, 36864
s_add_u32 s17, s18, 1048576
buffer_load_dwordx4 v3, s[8:11], s17 offen nt lds
s_add_u32 m0, s19, 40960
s_add_u32 s17, s18, 1310720
buffer_load_dwordx4 v3, s[8:11], s17 offen nt lds
s_add_u32 m0, s19, 45056
s_add_u32 s17, s18, 1572864
buffer_load_dwordx4 v3, s[8:11], s17 offen nt lds
s_add_u32 m0, s19, 49152
s_add_u32 s17, s18, 1835008
buffer_load_dwordx4 v3, s[8:11], s17 offen nt lds
s_mov_b32 s8, s38
s_mov_b32 s9, s39
s_mov_b32 s10, 4718592
s_mov_b32 s11, 0x20000
s_and_b32 s17, s62, 1
s_lshr_b32 s19, s62, 1
s_lshl_b32 s18, s63, 8
s_lshl_b32 s20, s17, 7
s_add_u32 s18, s18, s20
s_lshl_b32 s20, s19, 16
s_add_u32 s18, s18, s20
s_mul_i32 s17, s17, 16
s_add_u32 s19, s19, s17
s_lshl_b32 s19, s19, 10
s_add_u32 m0, s19, 73728
s_add_u32 s17, s18, 2097152
buffer_load_dwordx4 v3, s[8:11], s17 offen nt lds
s_add_u32 m0, s19, 77824
s_add_u32 s17, s18, 2359296
buffer_load_dwordx4 v3, s[8:11], s17 offen nt lds
s_add_u32 m0, s19, 81920
s_add_u32 s17, s18, 2621440
buffer_load_dwordx4 v3, s[8:11], s17 offen nt lds
s_add_u32 m0, s19, 86016
s_add_u32 s17, s18, 2883584
buffer_load_dwordx4 v3, s[8:11], s17 offen nt lds
s_mov_b32 s8, s38
s_mov_b32 s9, s39
s_mov_b32 s10, 4718592
s_mov_b32 s11, 0x20000
s_and_b32 s17, s62, 1
s_lshr_b32 s19, s62, 1
s_lshl_b32 s18, s63, 8
s_lshl_b32 s20, s17, 7
s_add_u32 s18, s18, s20
s_lshl_b32 s20, s19, 16
s_add_u32 s18, s18, s20
s_mul_i32 s17, s17, 16
s_add_u32 s19, s19, s17
s_lshl_b32 s19, s19, 10
s_add_u32 m0, s19, 110592
s_add_u32 s17, s18, 3145728
buffer_load_dwordx4 v3, s[8:11], s17 offen nt lds
s_add_u32 m0, s19, 114688
s_add_u32 s17, s18, 3407872
buffer_load_dwordx4 v3, s[8:11], s17 offen nt lds
s_add_u32 m0, s19, 118784
s_add_u32 s17, s18, 3670016
buffer_load_dwordx4 v3, s[8:11], s17 offen nt lds
s_add_u32 m0, s19, 122880
s_add_u32 s17, s18, 3932160
buffer_load_dwordx4 v3, s[8:11], s17 offen nt lds
s_mov_b32 s12, s56
s_mov_b32 s13, s57
s_mov_b32 s14, 2304
s_mov_b32 s15, 0x20000
buffer_load_ushort v24, v13, s[12:15], 0 offen
v_and_b32 v25, 0x1c, v1
v_cmp_eq_u32 vcc, 0, v25
v_lshlrev_b32 v26, 3, v19
s_nop 0
v_cndmask_b32 v250, v17, v26, vcc
v_and_b32 v25, 0xc, v1
v_cmp_eq_u32 vcc, 0, v25
s_nop 1
v_cndmask_b32 v251, v17, v13, vcc
v_lshlrev_b32 v237, 4, v1
s_cmp_lt_u32 s96, 18
s_cselect_b64 s[92:93], -1, 0
v_cndmask_b32 v243, v17, v26, s[92:93]
s_mov_b32 s84, 73728
s_and_b32 s89, s62, 3
s_lshl_b32 s89, s89, 11
s_add_u32 s88, s88, s89
s_add_u32 s89, s88, 458752
s_add_u32 s88, s88, 131072
v_add_u32 v241, s21, v237
s_mov_b32 s100, 131072
s_mov_b32 s101, 458752
v_cndmask_b32 v250, v17, v250, s[92:93]
v_mul_u32_u24 v25, 3641, v1
v_lshrrev_b32 v25, 16, v25
v_mul_u32_u24 v26, 18, v25
v_sub_u32 v26, v1, v26
v_mul_u32_u24 v5, 9216, v25
v_lshl_add_u32 v5, v26, 4, v5
v_cmp_gt_u32 s[26:27], 54, v1
v_bfe_u32 v25, v1, 2, 3
v_lshrrev_b32 v26, 1, v25
v_add_u32 v26, s62, v26
v_and_b32 v26, 3, v26
v_lshlrev_b32 v6, 7, v25
v_lshl_add_u32 v6, v26, 5, v6
v_and_b32 v26, 3, v1
v_lshl_add_u32 v6, v26, 3, v6
v_lshrrev_b32 v25, 5, v1
v_lshl_add_u32 v6, v25, 10, v6
v_and_b32 v26, 3, v1
v_lshrrev_b32 v25, 2, v1
v_mul_u32_u24 v7, 288, v25
v_lshl_add_u32 v7, v26, 3, v7
v_bfe_u32 v25, v1, 1, 1
v_lshrrev_b32 v26, 4, v1
v_lshlrev_b32 v26, 5, v26
v_and_b32 v27, 1, v1
v_lshl_add_u32 v26, v27, 4, v26
v_add_u32 v26, 147456, v26
v_mul_u32_u24 v8, 1152, v25
v_add_u32 v8, v8, v26
v_mul_u32_u24 v9, 384, v25
v_add_u32 v9, v9, v26
v_mul_u32_u24 v27, 2304, v25
v_sub_u32 v240, v26, v27
v_add_u32 v240, 2304, v240
v_and_b32 v27, 12, v1
v_cmp_ne_u32 vcc, 0, v27
v_mov_b32 v27, 1152
s_nop 0
v_cndmask_b32 v27, 0, v27, vcc
v_add_u32 v240, v240, v27
v_lshrrev_b32 v25, 4, v0
v_lshlrev_b32 v10, 6, v25
v_bfe_u32 v25, v0, 2, 1
v_lshl_add_u32 v10, v25, 5, v10
v_bfe_u32 v25, v0, 0, 1
v_lshl_add_u32 v10, v25, 4, v10
v_bfe_u32 v25, v0, 1, 1
v_lshl_add_u32 v10, v25, 3, v10
v_bfe_u32 v25, v0, 3, 1
v_lshl_add_u32 v10, v25, 2, v10
v_lshlrev_b32 v25, 2, v1
v_add_u32 v25, 4416, v25
v_cndmask_b32 v10, v25, v10, s[28:29]
v_add_u32 v10, 147456, v10
v_lshrrev_b32 v25, 4, v1
v_lshlrev_b32 v2, 6, v25
v_bfe_u32 v25, v1, 2, 1
v_lshl_add_u32 v2, v25, 5, v2
v_bfe_u32 v25, v1, 0, 1
v_lshl_add_u32 v2, v25, 4, v2
v_bfe_u32 v25, v1, 1, 1
v_lshl_add_u32 v2, v25, 3, v2
v_bfe_u32 v25, v1, 3, 1
v_lshl_add_u32 v2, v25, 2, v2
s_and_b32 s16, s62, 1
s_mul_i32 s16, s16, 384
s_add_u32 s16, s16, 147456
v_add_u32 v2, s16, v2
v_bfe_u32 v25, v1, 3, 1
v_lshlrev_b32 v25, 11, v25
v_and_b32 v26, 7, v1
v_lshl_add_u32 v25, v26, 3, v25
v_lshrrev_b32 v26, 4, v1
v_lshl_add_u32 v11, v26, 15, v25
v_cmp_gt_u32 vcc, 16, v1
v_lshlrev_b32 v25, 3, v1
s_nop 0
v_cndmask_b32 v12, v17, v25, vcc
v_lshlrev_b32 v25, 4, v0
v_cndmask_b32 v236, v17, v25, s[28:29]
s_mov_b32 s30, 0x3fb8aa3b
v_bfe_u32 v25, v1, 4, 1
v_lshlrev_b32 v25, 2, v25
v_lshrrev_b32 v26, 5, v1
v_lshl_add_u32 v25, v26, 6, v25
s_lshl_b32 s16, s62, 3
s_add_u32 s16, s16, 147456
v_add_u32 v238, s16, v25
v_and_b32 v25, 15, v1
v_cndmask_b32 v26, 1, 0, vcc
v_mov_b32 v39, 147456
v_lshl_add_u32 v239, v26, 6, v39
v_mul_u32_u24 v27, 272, v26
v_lshrrev_b32 v26, 1, v25
v_lshl_add_u32 v27, v26, 5, v27
v_and_b32 v26, 1, v1
v_lshl_add_u32 v27, v26, 2, v27
s_lshl_b32 s16, s62, 3
s_add_u32 s16, s16, 147456
v_add_u32 v0, s16, v27
v_bfe_u32 v25, v1, 1, 1
v_mul_u32_u24 v25, 272, v25
v_lshl_add_u32 v25, v26, 5, v25
v_lshrrev_b32 v26, 4, v1
v_lshl_add_u32 v25, v26, 6, v25
v_add_u32 v253, 147456, v25
s_lshl_b32 s16, s62, 12
s_lshl_b32 s17, s63, 6
s_add_u32 s31, s16, s17
v_cmp_gt_u32 s[86:87], 16, v1
v_and_b32 v25, 1, v1
v_cmp_eq_u32 vcc, 0, v25
v_mov_b32 v25, 0x44444444
v_mov_b32 v26, 0xeeeeeeee
v_cndmask_b32 v13, v26, v25, vcc
s_mov_b32 s98, 0x3ae38e39
s_mov_b32 s99, 0x3727c5ac
s_mov_b32 s95, 0x07060302
s_mov_b32 s97, 0x05040100
s_mov_b32 s85, 0x3f803f80
s_waitcnt lgkmcnt(0)
s_add_u32 s66, s65, 1
s_cmp_lg_u32 s62, 0
s_cbranch_scc1 L_5
s_getreg_b32 s16, hwreg(HW_REG_XCC_ID, 0, 4)
v_mov_b32 v26, s16
v_mov_b32 v27, s66
v_cmp_eq_u32 vcc, 0, v1
v_mov_b32 v25, 2147483648
s_nop 0
v_cndmask_b32 v25, v25, 0, vcc
s_lshl_b32 s16, s63, 3
buffer_store_dwordx2 v[26:27], v25, s[4:7], s16 offen offset:256 sc1
L_5:
s_waitcnt vmcnt(13)
v_lshlrev_b32 v232, 16, v232
v_lshlrev_b32 v233, 16, v233
v_lshlrev_b32 v252, 16, v252
v_lshlrev_b32 v234, 16, v234
v_lshlrev_b32 v40, 16, v32
v_and_b32 v41, 0xffff0000, v32
v_lshlrev_b32 v42, 16, v33
v_and_b32 v43, 0xffff0000, v33
v_add_f32 v50, v40, v41
v_add_f32 v51, v42, v43
v_mul_f32 v52, v40, v40
v_mul_f32 v53, v42, v42
v_fmac_f32 v52, v41, v41
v_fmac_f32 v53, v43, v43
v_permlane32_swap_b32 v50, v51
s_nop 0
v_permlane32_swap_b32 v52, v53
v_add_f32 v50, v50, v51
v_add_f32 v52, v52, v53
s_nop 1
v_permlane16_swap_b32 v50, v52
v_add_f32 v50, v50, v52
s_nop 1
v_add_f32_dpp v50, v50, v50 quad_perm:[1,0,3,2] row_mask:0xf bank_mask:0xf
s_nop 1
v_add_f32_dpp v50, v50, v50 quad_perm:[2,3,0,1] row_mask:0xf bank_mask:0xf
s_nop 1
v_add_f32_dpp v50, v50, v50 row_half_mirror row_mask:0xf bank_mask:0xf
s_nop 1
v_add_f32_dpp v50, v50, v50 row_mirror row_mask:0xf bank_mask:0xf
ds_write_b32 v238, v50 offset:8704
s_waitcnt lgkmcnt(0)
s_barrier
ds_read_b128 v[44:47], v39 offset:8704
ds_read_b128 v[48:51], v39 offset:8720
ds_read_b64 v[52:53], v39 offset:8736
ds_read_b128 v[54:57], v39 offset:8768
ds_read_b128 v[58:61], v39 offset:8784
ds_read_b64 v[62:63], v39 offset:8800
s_waitcnt lgkmcnt(0)
v_pk_add_f32 v[44:45], v[44:45], v[46:47]
v_pk_add_f32 v[48:49], v[48:49], v[50:51]
v_pk_add_f32 v[44:45], v[44:45], v[52:53]
v_pk_add_f32 v[44:45], v[44:45], v[48:49]
v_pk_mul_f32 v[44:45], v[44:45], s[98:99] op_sel_hi:[1,0]
v_pk_add_f32 v[54:55], v[54:55], v[56:57]
v_pk_add_f32 v[58:59], v[58:59], v[60:61]
v_pk_add_f32 v[54:55], v[54:55], v[62:63]
v_pk_add_f32 v[54:55], v[54:55], v[58:59]
v_pk_mul_f32 v[54:55], v[54:55], s[98:99] op_sel_hi:[1,0]
v_fma_f32 v46, -v44, v44, v45
v_fma_f32 v47, -v54, v54, v55
v_mov_b32 v45, v54
v_max_f32 v46, 0, v46
v_max_f32 v47, 0, v47
v_cvt_pk_bf16_f32 v48, v44, v45
v_lshlrev_b32 v44, 16, v48
v_and_b32 v45, 0xffff0000, v48
v_cvt_pk_bf16_f32 v48, v46, v47
v_lshlrev_b32 v46, 16, v48
v_and_b32 v47, 0xffff0000, v48
v_add_f32 v46, s99, v46
v_add_f32 v47, s99, v47
v_cvt_pk_bf16_f32 v48, v46, v47
v_lshlrev_b32 v46, 16, v48
v_and_b32 v47, 0xffff0000, v48
v_sqrt_f32 v46, v46
v_sqrt_f32 v47, v47
v_sub_f32 v40, v40, v44
v_sub_f32 v41, v41, v44
v_sub_f32 v42, v42, v45
v_sub_f32 v43, v43, v45
v_cvt_pk_bf16_f32 v48, v46, v47
v_lshlrev_b32 v46, 16, v48
v_and_b32 v47, 0xffff0000, v48
v_rcp_f32 v46, v46
v_rcp_f32 v47, v47
v_cvt_pk_bf16_f32 v48, v40, v41
v_lshlrev_b32 v40, 16, v48
v_and_b32 v41, 0xffff0000, v48
v_cvt_pk_bf16_f32 v49, v42, v43
v_lshlrev_b32 v42, 16, v49
v_and_b32 v43, 0xffff0000, v49
v_mul_f32 v40, v46, v40
v_mul_f32 v41, v46, v41
v_mul_f32 v42, v47, v42
v_mul_f32 v43, v47, v43
v_cvt_pk_bf16_f32 v48, v40, v41
v_lshlrev_b32 v40, 16, v48
v_and_b32 v41, 0xffff0000, v48
v_cvt_pk_bf16_f32 v49, v42, v43
v_lshlrev_b32 v42, 16, v49
v_and_b32 v43, 0xffff0000, v49
s_waitcnt vmcnt(19)
s_barrier
s_lshr_b32 s16, s62, 2
s_mul_i32 s16, s16, 16384
v_add_u32 v14, s16, v6
v_add_u32 v15, 0x10000, v14
ds_read_b64_tr_b16 v[144:145], v14 offset:0
ds_read_b64_tr_b16 v[146:147], v14 offset:2048
ds_read_b64_tr_b16 v[148:149], v14 offset:4096
ds_read_b64_tr_b16 v[150:151], v14 offset:6144
ds_read_b64_tr_b16 v[152:153], v14 offset:8192
ds_read_b64_tr_b16 v[154:155], v14 offset:10240
ds_read_b64_tr_b16 v[156:157], v14 offset:12288
ds_read_b64_tr_b16 v[158:159], v14 offset:14336
s_waitcnt lgkmcnt(0)
s_waitcnt vmcnt(9)
s_barrier
s_mov_b32 s8, s38
s_mov_b32 s9, s39
s_mov_b32 s10, 4718592
s_mov_b32 s11, 0x20000
s_and_b32 s17, s62, 1
s_lshr_b32 s19, s62, 1
s_lshl_b32 s18, s63, 8
s_lshl_b32 s20, s17, 7
s_add_u32 s18, s18, s20
s_lshl_b32 s20, s19, 16
s_add_u32 s18, s18, s20
s_mul_i32 s17, s17, 8
s_add_u32 s19, s19, s17
s_lshl_b32 s19, s19, 10
s_add_u32 m0, s19, 0
s_add_u32 s17, s18, 4194304
buffer_load_dwordx4 v3, s[8:11], s17 offen nt lds
s_add_u32 m0, s19, 4096
s_add_u32 s17, s18, 4456448
buffer_load_dwordx4 v3, s[8:11], s17 offen nt lds
s_lshr_b32 s16, s62, 2
s_mul_i32 s16, s16, 16384
v_add_u32 v14, s16, v6
v_add_u32 v14, 36864, v14
v_add_u32 v15, 0x10000, v14
ds_read_b64_tr_b16 v[160:161], v14 offset:0
ds_read_b64_tr_b16 v[162:163], v14 offset:2048
ds_read_b64_tr_b16 v[164:165], v14 offset:4096
ds_read_b64_tr_b16 v[166:167], v14 offset:6144
ds_read_b64_tr_b16 v[168:169], v14 offset:8192
ds_read_b64_tr_b16 v[170:171], v14 offset:10240
ds_read_b64_tr_b16 v[172:173], v14 offset:12288
ds_read_b64_tr_b16 v[174:175], v14 offset:14336
s_waitcnt lgkmcnt(0)
s_mov_b32 s72, 4096
s_mov_b32 s73, 8704
s_waitcnt vmcnt(7)
s_barrier
buffer_load_dwordx4 v[16:19], v236, s[4:7], s72 offen sc1
buffer_load_dwordx4 v[20:23], v236, s[4:7], s73 offen sc1
s_mov_b32 s8, s40
s_mov_b32 s9, s41
s_mov_b32 s10, 4718592
s_mov_b32 s11, 0x20000
s_mul_i32 s18, s63, 147456
s_and_b32 s17, s62, 3
s_mul_i32 s17, s17, 9216
s_add_u32 s18, s18, s17
s_lshr_b32 s17, s62, 2
s_lshl_b32 s17, s17, 7
s_add_u32 s18, s18, s17
s_lshl_b32 s19, s62, 10
s_cmp_gt_u32 s62, 3
s_cbranch_scc1 L_6
s_add_u32 m0, s19, 69632
s_add_u32 s17, s18, 1024
buffer_load_dwordx4 v4, s[8:11], s17 offen nt lds
L_6:
s_add_u32 m0, s19, 36864
s_add_u32 s17, s18, 0
buffer_load_dwordx4 v4, s[8:11], s17 offen nt lds
s_add_u32 m0, s19, 45056
s_add_u32 s17, s18, 256
buffer_load_dwordx4 v4, s[8:11], s17 offen nt lds
s_add_u32 m0, s19, 53248
s_add_u32 s17, s18, 512
buffer_load_dwordx4 v4, s[8:11], s17 offen nt lds
s_add_u32 m0, s19, 61440
s_add_u32 s17, s18, 768
buffer_load_dwordx4 v4, s[8:11], s17 offen nt lds
s_lshr_b32 s16, s62, 2
s_mul_i32 s16, s16, 16384
v_add_u32 v14, s16, v6
v_add_u32 v14, 73728, v14
v_add_u32 v15, 0x10000, v14
ds_read_b64_tr_b16 v[176:177], v14 offset:0
ds_read_b64_tr_b16 v[178:179], v14 offset:2048
ds_read_b64_tr_b16 v[180:181], v14 offset:4096
ds_read_b64_tr_b16 v[182:183], v14 offset:6144
ds_read_b64_tr_b16 v[184:185], v14 offset:8192
ds_read_b64_tr_b16 v[186:187], v14 offset:10240
ds_read_b64_tr_b16 v[188:189], v14 offset:12288
ds_read_b64_tr_b16 v[190:191], v14 offset:14336
s_waitcnt lgkmcnt(0)
s_waitcnt vmcnt(9)
s_barrier
s_mov_b32 s8, s40
s_mov_b32 s9, s41
s_mov_b32 s10, 4718592
s_mov_b32 s11, 0x20000
s_mul_i32 s18, s63, 147456
s_and_b32 s17, s62, 3
s_mul_i32 s17, s17, 9216
s_add_u32 s18, s18, s17
s_lshr_b32 s17, s62, 2
s_lshl_b32 s17, s17, 7
s_add_u32 s18, s18, s17
s_lshl_b32 s19, s62, 10
s_cmp_gt_u32 s62, 3
s_cbranch_scc1 L_7
s_add_u32 m0, s19, 106496
s_add_u32 s17, s18, 37888
buffer_load_dwordx4 v4, s[8:11], s17 offen nt lds
L_7:
s_add_u32 m0, s19, 73728
s_add_u32 s17, s18, 36864
buffer_load_dwordx4 v4, s[8:11], s17 offen nt lds
s_add_u32 m0, s19, 81920
s_add_u32 s17, s18, 37120
buffer_load_dwordx4 v4, s[8:11], s17 offen nt lds
s_add_u32 m0, s19, 90112
s_add_u32 s17, s18, 37376
buffer_load_dwordx4 v4, s[8:11], s17 offen nt lds
s_add_u32 m0, s19, 98304
s_add_u32 s17, s18, 37632
buffer_load_dwordx4 v4, s[8:11], s17 offen nt lds
s_lshr_b32 s16, s62, 2
s_mul_i32 s16, s16, 16384
v_add_u32 v14, s16, v6
v_add_u32 v14, 110592, v14
v_add_u32 v15, 0x10000, v14
ds_read_b64_tr_b16 v[192:193], v14 offset:0
ds_read_b64_tr_b16 v[194:195], v14 offset:2048
ds_read_b64_tr_b16 v[196:197], v14 offset:4096
ds_read_b64_tr_b16 v[198:199], v14 offset:6144
ds_read_b64_tr_b16 v[200:201], v14 offset:8192
ds_read_b64_tr_b16 v[202:203], v14 offset:10240
ds_read_b64_tr_b16 v[204:205], v14 offset:12288
ds_read_b64_tr_b16 v[206:207], v14 offset:14336
s_waitcnt lgkmcnt(0)
s_waitcnt vmcnt(10)
s_barrier
buffer_load_dwordx4 v[52:55], v236, s[4:7], s72 offen sc1
buffer_load_dwordx4 v[56:59], v236, s[4:7], s73 offen sc1
s_mov_b32 s8, s40
s_mov_b32 s9, s41
s_mov_b32 s10, 4718592
s_mov_b32 s11, 0x20000
s_mul_i32 s18, s63, 147456
s_and_b32 s17, s62, 3
s_mul_i32 s17, s17, 9216
s_add_u32 s18, s18, s17
s_lshr_b32 s17, s62, 2
s_lshl_b32 s17, s17, 7
s_add_u32 s18, s18, s17
s_lshl_b32 s19, s62, 10
s_cmp_gt_u32 s62, 3
s_cbranch_scc1 L_8
s_add_u32 m0, s19, 143360
s_add_u32 s17, s18, 74752
buffer_load_dwordx4 v4, s[8:11], s17 offen nt lds
L_8:
s_add_u32 m0, s19, 110592
s_add_u32 s17, s18, 73728
buffer_load_dwordx4 v4, s[8:11], s17 offen nt lds
s_add_u32 m0, s19, 118784
s_add_u32 s17, s18, 73984
buffer_load_dwordx4 v4, s[8:11], s17 offen nt lds
s_add_u32 m0, s19, 126976
s_add_u32 s17, s18, 74240
buffer_load_dwordx4 v4, s[8:11], s17 offen nt lds
s_add_u32 m0, s19, 135168
s_add_u32 s17, s18, 74496
buffer_load_dwordx4 v4, s[8:11], s17 offen nt lds
s_lshr_b32 s16, s62, 2
s_mul_i32 s16, s16, 8192
v_add_u32 v14, s16, v6
v_add_u32 v15, 0x10000, v14
ds_read_b64_tr_b16 v[208:209], v14 offset:0
ds_read_b64_tr_b16 v[210:211], v14 offset:2048
ds_read_b64_tr_b16 v[212:213], v14 offset:4096
ds_read_b64_tr_b16 v[214:215], v14 offset:6144
s_waitcnt lgkmcnt(0)
s_waitcnt vmcnt(10)
s_barrier
s_mov_b32 s8, s40
s_mov_b32 s9, s41
s_mov_b32 s10, 4718592
s_mov_b32 s11, 0x20000
s_mul_i32 s18, s63, 147456
s_and_b32 s17, s62, 3
s_mul_i32 s17, s17, 9216
s_add_u32 s18, s18, s17
s_lshr_b32 s17, s62, 2
s_lshl_b32 s17, s17, 7
s_add_u32 s18, s18, s17
s_lshl_b32 s19, s62, 10
s_cmp_gt_u32 s62, 3
s_cbranch_scc1 L_9
s_add_u32 m0, s19, 32768
s_add_u32 s17, s18, 111616
buffer_load_dwordx4 v4, s[8:11], s17 offen nt lds
L_9:
s_add_u32 m0, s19, 0
s_add_u32 s17, s18, 110592
buffer_load_dwordx4 v4, s[8:11], s17 offen nt lds
s_add_u32 m0, s19, 8192
s_add_u32 s17, s18, 110848
buffer_load_dwordx4 v4, s[8:11], s17 offen nt lds
s_add_u32 m0, s19, 16384
s_add_u32 s17, s18, 111104
buffer_load_dwordx4 v4, s[8:11], s17 offen nt lds
s_add_u32 m0, s19, 24576
s_add_u32 s17, s18, 111360
buffer_load_dwordx4 v4, s[8:11], s17 offen nt lds
s_lshr_b32 s16, s62, 2
s_lshl_b32 s16, s16, 12
v_add_u32 v14, s16, v6
v_add_u32 v14, 36864, v14
v_add_u32 v15, 0x10000, v14
ds_read_b64_tr_b16 v[64:65], v14 offset:0
ds_read_b64_tr_b16 v[66:67], v14 offset:2048
ds_read_b64_tr_b16 v[80:81], v14 offset:8192
ds_read_b64_tr_b16 v[82:83], v14 offset:10240
ds_read_b64_tr_b16 v[96:97], v14 offset:16384
ds_read_b64_tr_b16 v[98:99], v14 offset:18432
ds_read_b64_tr_b16 v[112:113], v14 offset:24576
ds_read_b64_tr_b16 v[114:115], v14 offset:26624
s_cmp_gt_u32 s62, 3
s_cbranch_scc1 L_10
ds_read_b64_tr_b16 v[128:129], v14 offset:32768
ds_read_b64_tr_b16 v[130:131], v14 offset:34816
L_10:
s_waitcnt lgkmcnt(0)
s_waitcnt vmcnt(18)
v_cmp_ne_u32 vcc, s66, v17
v_cmp_ne_u32 s[22:23], s66, v19
s_nop 0
s_or_b64 vcc, vcc, s[22:23]
v_cmp_ne_u32 s[22:23], s66, v21
s_nop 0
s_or_b64 vcc, vcc, s[22:23]
v_cmp_ne_u32 s[22:23], s66, v23
s_nop 0
s_or_b64 vcc, vcc, s[22:23]
s_and_b64 vcc, vcc, s[28:29]
s_cbranch_vccz L_f1ok
s_waitcnt vmcnt(8)
v_mov_b32 v16, v52
v_mov_b32 v17, v53
v_mov_b32 v18, v54
v_mov_b32 v19, v55
v_mov_b32 v20, v56
v_mov_b32 v21, v57
v_mov_b32 v22, v58
v_mov_b32 v23, v59
s_mov_b32 s67, 0
s_branch F1c_13
F1_11:
buffer_load_dwordx4 v[16:19], v236, s[4:7], s72 offen sc1
buffer_load_dwordx4 v[20:23], v236, s[4:7], s73 offen sc1
s_waitcnt vmcnt(0)
F1c_13:
s_mov_b64 s[90:91], 0
v_cmp_ne_u32 vcc, s66, v17
v_cmp_ne_u32 s[22:23], s66, v19
s_nop 0
s_or_b64 vcc, vcc, s[22:23]
v_cmp_ne_u32 s[22:23], s66, v21
s_nop 0
s_or_b64 vcc, vcc, s[22:23]
v_cmp_ne_u32 s[22:23], s66, v23
s_nop 0
s_or_b64 vcc, vcc, s[22:23]
s_and_b64 vcc, vcc, s[28:29]
s_or_b64 s[90:91], s[90:91], vcc
s_cmp_eq_u64 s[90:91], 0
s_cbranch_scc1 F1d_12
s_sleep 2
s_add_u32 s67, s67, 1
s_cmp_lt_u32 s67, 262144
s_cbranch_scc1 F1_11
F1d_12:
L_f1ok:
v_lshlrev_b32 v28, 16, v16
v_lshlrev_b32 v29, 16, v18
v_and_b32 v30, 0xffff0000, v16
v_and_b32 v31, 0xffff0000, v18
v_lshlrev_b32 v24, 16, v20
v_lshlrev_b32 v25, 16, v22
v_and_b32 v26, 0xffff0000, v20
v_and_b32 v27, 0xffff0000, v22
v_add_f32 v24, 1.0, v24
v_add_f32 v25, 1.0, v25
v_add_f32 v26, 1.0, v26
v_add_f32 v27, 1.0, v27
v_cvt_pk_bf16_f32 v16, v24, v25
v_lshlrev_b32 v24, 16, v16
v_and_b32 v25, 0xffff0000, v16
v_cvt_pk_bf16_f32 v16, v26, v27
v_lshlrev_b32 v26, 16, v16
v_and_b32 v27, 0xffff0000, v16
v_mul_f32 v40, v40, v24
v_mul_f32 v41, v41, v25
v_mul_f32 v42, v42, v26
v_mul_f32 v43, v43, v27
v_cvt_pk_bf16_f32 v46, v40, v41
v_lshlrev_b32 v40, 16, v46
v_and_b32 v41, 0xffff0000, v46
v_cvt_pk_bf16_f32 v47, v42, v43
v_lshlrev_b32 v42, 16, v47
v_and_b32 v43, 0xffff0000, v47
v_add_f32 v40, v40, v28
v_add_f32 v41, v41, v29
v_add_f32 v42, v42, v30
v_add_f32 v43, v43, v31
v_cvt_pk_bf16_f32 v46, v40, v41
v_cvt_pk_bf16_f32 v47, v42, v43
ds_write_b32 v10, v46 offset:2304
ds_write_b32 v10, v47 offset:3456
v_mov_b32 v60, 0
v_mov_b32 v61, 0
v_mov_b32 v62, 0
v_mov_b32 v63, 0
s_waitcnt lgkmcnt(0)
s_barrier
ds_read_b128 v[16:19], v8 offset:2304
ds_read_b128 v[20:23], v8 offset:2432
ds_read_b128 v[24:27], v8 offset:2560
ds_read_b128 v[28:31], v8 offset:2688
ds_read_b128 v[32:35], v8 offset:2816
ds_read_b128 v[36:39], v8 offset:2944
ds_read_b128 v[40:43], v8 offset:3072
ds_read_b128 v[44:47], v8 offset:3200
ds_read_b128 v[48:51], v8 offset:3328
s_waitcnt lgkmcnt(8)
v_smfmac_f32_16x16x64_bf16 v[60:63], v[16:19], v[144:151], v13
s_waitcnt lgkmcnt(7)
v_smfmac_f32_16x16x64_bf16 v[60:63], v[20:23], v[152:159], v13
s_waitcnt lgkmcnt(6)
v_smfmac_f32_16x16x64_bf16 v[60:63], v[24:27], v[160:167], v13
s_waitcnt lgkmcnt(5)
v_smfmac_f32_16x16x64_bf16 v[60:63], v[28:31], v[168:175], v13
s_waitcnt lgkmcnt(4)
v_smfmac_f32_16x16x64_bf16 v[60:63], v[32:35], v[176:183], v13
s_waitcnt lgkmcnt(3)
v_smfmac_f32_16x16x64_bf16 v[60:63], v[36:39], v[184:191], v13
s_waitcnt lgkmcnt(2)
v_smfmac_f32_16x16x64_bf16 v[60:63], v[40:43], v[192:199], v13
s_waitcnt lgkmcnt(1)
v_smfmac_f32_16x16x64_bf16 v[60:63], v[44:47], v[200:207], v13
s_waitcnt lgkmcnt(0)
v_smfmac_f32_16x16x64_bf16 v[60:63], v[48:51], v[208:215], v13
s_lshl_b32 s16, s63, 10
s_lshl_b32 s17, s62, 7
s_add_u32 s16, s16, s17
s_add_u32 s16, s16, 32768
s_nop 3
v_add_f32 v60, v60, v61
v_add_f32 v62, v62, v63
v_cvt_pk_bf16_f32 v60, v60, v62
v_mov_b32 v61, s66
buffer_store_dwordx2 v[60:61], v12, s[4:7], s16 offen sc1
s_waitcnt vmcnt(10)
s_barrier
s_mov_b32 s8, s48
s_mov_b32 s9, s49
s_mov_b32 s10, 5308416
s_mov_b32 s11, 0x20000
s_and_b32 s17, s62, 1
s_mul_i32 s17, s17, 9216
s_mul_i32 s18, s63, 165888
s_add_u32 s18, s18, s17
s_lshr_b32 s17, s62, 1
s_lshl_b32 s17, s17, 7
s_add_u32 s18, s18, s17
s_lshl_b32 s19, s62, 10
s_cmp_gt_u32 s62, 1
s_cbranch_scc1 L_14
s_add_u32 m0, s19, 53248
s_add_u32 s17, s18, 148480
buffer_load_dwordx4 v4, s[8:11], s17 offen nt lds
L_14:
s_add_u32 m0, s19, 36864
s_add_u32 s17, s18, 147456
buffer_load_dwordx4 v4, s[8:11], s17 offen nt lds
s_add_u32 m0, s19, 45056
s_add_u32 s17, s18, 147968
buffer_load_dwordx4 v4, s[8:11], s17 offen nt lds
s_lshr_b32 s16, s62, 2
s_lshl_b32 s16, s16, 12
v_add_u32 v14, s16, v6
v_add_u32 v14, 73728, v14
v_add_u32 v15, 0x10000, v14
ds_read_b64_tr_b16 v[68:69], v14 offset:0
ds_read_b64_tr_b16 v[70:71], v14 offset:2048
ds_read_b64_tr_b16 v[84:85], v14 offset:8192
ds_read_b64_tr_b16 v[86:87], v14 offset:10240
ds_read_b64_tr_b16 v[100:101], v14 offset:16384
ds_read_b64_tr_b16 v[102:103], v14 offset:18432
ds_read_b64_tr_b16 v[116:117], v14 offset:24576
ds_read_b64_tr_b16 v[118:119], v14 offset:26624
s_cmp_gt_u32 s62, 3
s_cbranch_scc1 L_15
ds_read_b64_tr_b16 v[132:133], v14 offset:32768
ds_read_b64_tr_b16 v[134:135], v14 offset:34816
L_15:
s_waitcnt lgkmcnt(0)
s_waitcnt vmcnt(6)
s_barrier
v_cmp_gt_u32 s[24:25], 32, v1
v_lshlrev_b32 v56, 3, v1
s_mov_b32 s72, 13312
s_mov_b32 s73, 17920
s_mov_b32 s74, 22528
s_mov_b32 s75, 27136
buffer_load_dwordx4 v[40:43], v236, s[4:7], s73 offen sc1
buffer_load_dwordx4 v[44:47], v236, s[4:7], s74 offen sc1
buffer_load_dwordx2 v[54:55], v56, s[4:7], 0 offen offset:256 sc1
buffer_load_dwordx2 v[48:49], v243, s[4:7], s72 offen sc1
buffer_load_dwordx2 v[58:59], v243, s[4:7], s74 offen sc1
buffer_load_dwordx2 v[50:51], v243, s[4:7], s75 offen sc1
v_mov_b32 v24, 384
v_cndmask_b32 v3, v24, 0, s[86:87]
v_bfe_u32 v24, v1, 3, 1
v_lshl_add_u32 v3, v24, 5, v3
v_bfe_u32 v24, v1, 2, 1
v_lshl_add_u32 v3, v24, 3, v3
v_bfe_u32 v24, v1, 1, 1
v_lshl_add_u32 v3, v24, 4, v3
v_bfe_u32 v24, v1, 0, 1
v_lshl_add_u32 v3, v24, 1, v3
s_lshr_b32 s16, s62, 1
s_lshl_b32 s16, s16, 6
s_and_b32 s17, s62, 1
s_lshl_b32 s17, s17, 2
s_add_u32 s16, s16, s17
s_add_u32 s16, s16, 147456
v_add_u32 v3, s16, v3
s_mov_b32 s8, s44
s_mov_b32 s9, s45
s_mov_b32 s10, 5308416
s_mov_b32 s11, 0x20000
s_mul_i32 s18, s63, 288
s_mul_i32 s17, s62, 27648
s_add_u32 s18, s18, s17
s_mul_i32 s19, s62, 864
s_mov_b64 exec, s[26:27]
s_add_u32 m0, s19, 73728
s_add_u32 s17, s18, 0
buffer_load_dwordx4 v5, s[8:11], s17 offen  lds
s_add_u32 m0, s19, 80640
s_add_u32 s17, s18, 221184
buffer_load_dwordx4 v5, s[8:11], s17 offen  lds
s_add_u32 m0, s19, 87552
s_add_u32 s17, s18, 442368
buffer_load_dwordx4 v5, s[8:11], s17 offen  lds
s_add_u32 m0, s19, 94464
s_add_u32 s17, s18, 663552
buffer_load_dwordx4 v5, s[8:11], s17 offen  lds
s_mov_b64 exec, -1
s_lshr_b32 s16, s62, 2
s_lshl_b32 s16, s16, 12
v_add_u32 v14, s16, v6
v_add_u32 v14, 110592, v14
v_add_u32 v15, 0x10000, v14
ds_read_b64_tr_b16 v[72:73], v14 offset:0
ds_read_b64_tr_b16 v[74:75], v14 offset:2048
ds_read_b64_tr_b16 v[88:89], v14 offset:8192
ds_read_b64_tr_b16 v[90:91], v14 offset:10240
ds_read_b64_tr_b16 v[104:105], v14 offset:16384
ds_read_b64_tr_b16 v[106:107], v14 offset:18432
ds_read_b64_tr_b16 v[120:121], v14 offset:24576
ds_read_b64_tr_b16 v[122:123], v14 offset:26624
s_cmp_gt_u32 s62, 3
s_cbranch_scc1 L_16
ds_read_b64_tr_b16 v[136:137], v14 offset:32768
ds_read_b64_tr_b16 v[138:139], v14 offset:34816
L_16:
s_waitcnt lgkmcnt(0)
s_waitcnt vmcnt(12)
s_barrier
s_mov_b32 s8, s44
s_mov_b32 s9, s45
s_mov_b32 s10, 5308416
s_mov_b32 s11, 0x20000
s_mul_i32 s18, s63, 288
s_mul_i32 s17, s62, 27648
s_add_u32 s18, s18, s17
s_mul_i32 s19, s62, 864
s_mov_b64 exec, s[26:27]
s_add_u32 m0, s19, 110592
s_add_u32 s17, s18, 884736
buffer_load_dwordx4 v5, s[8:11], s17 offen  lds
s_add_u32 m0, s19, 117504
s_add_u32 s17, s18, 1105920
buffer_load_dwordx4 v5, s[8:11], s17 offen  lds
s_add_u32 m0, s19, 124416
s_add_u32 s17, s18, 1327104
buffer_load_dwordx4 v5, s[8:11], s17 offen  lds
s_add_u32 m0, s19, 131328
s_add_u32 s17, s18, 1548288
buffer_load_dwordx4 v5, s[8:11], s17 offen  lds
s_mov_b64 exec, -1
s_lshr_b32 s16, s62, 2
s_lshl_b32 s16, s16, 12
v_add_u32 v14, s16, v6
v_add_u32 v15, 0x10000, v14
ds_read_b64_tr_b16 v[76:77], v14 offset:0
ds_read_b64_tr_b16 v[78:79], v14 offset:2048
ds_read_b64_tr_b16 v[92:93], v14 offset:8192
ds_read_b64_tr_b16 v[94:95], v14 offset:10240
ds_read_b64_tr_b16 v[108:109], v14 offset:16384
ds_read_b64_tr_b16 v[110:111], v14 offset:18432
ds_read_b64_tr_b16 v[124:125], v14 offset:24576
ds_read_b64_tr_b16 v[126:127], v14 offset:26624
s_cmp_gt_u32 s62, 3
s_cbranch_scc1 L_17
ds_read_b64_tr_b16 v[140:141], v14 offset:32768
ds_read_b64_tr_b16 v[142:143], v14 offset:34816
L_17:
s_waitcnt lgkmcnt(0)
s_waitcnt vmcnt(14)
s_barrier
s_mov_b32 s8, s44
s_mov_b32 s9, s45
s_mov_b32 s10, 5308416
s_mov_b32 s11, 0x20000
s_mul_i32 s18, s63, 288
s_mul_i32 s17, s62, 27648
s_add_u32 s18, s18, s17
s_mul_i32 s19, s62, 864
s_mov_b64 exec, s[26:27]
s_add_u32 m0, s19, 0
s_add_u32 s17, s18, 1769472
buffer_load_dwordx4 v5, s[8:11], s17 offen  lds
s_add_u32 m0, s19, 6912
s_add_u32 s17, s18, 1990656
buffer_load_dwordx4 v5, s[8:11], s17 offen  lds
s_add_u32 m0, s19, 13824
s_add_u32 s17, s18, 2211840
buffer_load_dwordx4 v5, s[8:11], s17 offen  lds
s_add_u32 m0, s19, 20736
s_add_u32 s17, s18, 2433024
buffer_load_dwordx4 v5, s[8:11], s17 offen  lds
s_mov_b64 exec, -1
s_lshr_b32 s16, s62, 2
s_lshl_b32 s16, s16, 11
v_add_u32 v14, s16, v6
v_add_u32 v14, 36864, v14
v_add_u32 v15, 0x10000, v14
ds_read_b64_tr_b16 v[224:225], v14 offset:0
ds_read_b64_tr_b16 v[226:227], v14 offset:4096
ds_read_b64_tr_b16 v[228:229], v14 offset:8192
ds_read_b64_tr_b16 v[230:231], v14 offset:12288
s_cmp_gt_u32 s62, 3
s_cbranch_scc1 L_18
ds_read_b64_tr_b16 v[222:223], v14 offset:16384
L_18:
s_waitcnt lgkmcnt(0)
s_waitcnt vmcnt(8)
s_barrier
s_mov_b32 s8, s44
s_mov_b32 s9, s45
s_mov_b32 s10, 5308416
s_mov_b32 s11, 0x20000
s_mul_i32 s18, s63, 288
s_mul_i32 s17, s62, 27648
s_add_u32 s18, s18, s17
s_mul_i32 s19, s62, 864
s_mov_b64 exec, s[26:27]
s_add_u32 m0, s19, 36864
s_add_u32 s17, s18, 2654208
buffer_load_dwordx4 v5, s[8:11], s17 offen  lds
s_add_u32 m0, s19, 43776
s_add_u32 s17, s18, 2875392
buffer_load_dwordx4 v5, s[8:11], s17 offen  lds
s_add_u32 m0, s19, 50688
s_add_u32 s17, s18, 3096576
buffer_load_dwordx4 v5, s[8:11], s17 offen  lds
s_add_u32 m0, s19, 57600
s_add_u32 s17, s18, 3317760
buffer_load_dwordx4 v5, s[8:11], s17 offen  lds
s_mov_b64 exec, -1
s_lshl_b32 s16, s62, 5
v_add_u32 v14, s16, v7
v_add_u32 v14, 73728, v14
v_add_u32 v15, 0x10000, v14
ds_read_b64_tr_b16 v[144:145], v14 offset:0
ds_read_b64_tr_b16 v[146:147], v14 offset:4608
ds_read_b64_tr_b16 v[148:149], v14 offset:9216
ds_read_b64_tr_b16 v[150:151], v14 offset:13824
ds_read_b64_tr_b16 v[152:153], v14 offset:18432
ds_read_b64_tr_b16 v[154:155], v14 offset:23040
s_cmp_lg_u32 s62, 4
s_cbranch_scc1 L_19
ds_read_b64_tr_b16 v[128:129], v14 offset:128
ds_read_b64_tr_b16 v[130:131], v14 offset:4736
ds_read_b64_tr_b16 v[132:133], v14 offset:9344
ds_read_b64_tr_b16 v[134:135], v14 offset:13952
L_19:
s_cmp_lg_u32 s62, 5
s_cbranch_scc1 L_20
ds_read_b64_tr_b16 v[128:129], v14 offset:18528
ds_read_b64_tr_b16 v[130:131], v14 offset:23136
L_20:
s_waitcnt lgkmcnt(0)
s_mov_b32 s67, 0
s_branch G2c_23
G2_21:
buffer_load_dwordx4 v[40:43], v236, s[4:7], s73 offen sc1
buffer_load_dwordx4 v[44:47], v236, s[4:7], s74 offen sc1
buffer_load_dwordx2 v[54:55], v56, s[4:7], 0 offen offset:256 sc1
buffer_load_dwordx2 v[48:49], v243, s[4:7], s72 offen sc1
buffer_load_dwordx2 v[58:59], v243, s[4:7], s74 offen sc1
buffer_load_dwordx2 v[50:51], v243, s[4:7], s75 offen sc1
s_waitcnt vmcnt(0)
G2c_23:
s_mov_b64 s[90:91], 0
v_cmp_ne_u32 vcc, s66, v41
v_cmp_ne_u32 s[22:23], s66, v43
s_nop 0
s_or_b64 vcc, vcc, s[22:23]
v_cmp_ne_u32 s[22:23], s66, v45
s_nop 0
s_or_b64 vcc, vcc, s[22:23]
v_cmp_ne_u32 s[22:23], s66, v47
s_nop 0
s_or_b64 vcc, vcc, s[22:23]
s_and_b64 vcc, vcc, s[28:29]
s_or_b64 s[90:91], s[90:91], vcc
v_cmp_ne_u32 vcc, s66, v55
s_nop 0
s_and_b64 vcc, vcc, s[24:25]
s_or_b64 s[90:91], s[90:91], vcc
v_cmp_ne_u32 vcc, s66, v49
v_cmp_ne_u32 s[22:23], s66, v51
s_nop 0
s_or_b64 vcc, vcc, s[22:23]
v_cmp_ne_u32 s[22:23], s66, v59
s_nop 0
s_or_b64 vcc, vcc, s[22:23]
s_and_b64 vcc, vcc, s[92:93]
s_or_b64 s[90:91], s[90:91], vcc
s_cmp_eq_u64 s[90:91], 0
s_cbranch_scc1 G2d_22
s_sleep 2
s_add_u32 s67, s67, 1
s_cmp_lt_u32 s67, 262144
s_cbranch_scc1 G2_21
G2d_22:
v_readfirstlane_b32 s16, v54
s_nop 1
v_cmp_ne_u32 vcc, s16, v54
s_nop 0
s_and_b64 vcc, vcc, s[24:25]
s_cmp_eq_u64 vcc, 0
s_cselect_b32 s68, 1, 0
v_mov_b32 v28, -1
v_mov_b32 v29, -1
v_mov_b32 v30, -1
v_mov_b32 v31, -1
s_cmp_eq_u32 s68, 0
s_cbranch_scc1 L_24
buffer_store_dwordx4 v[28:31], v241, s[4:7], s100 offen
L_25:
s_cmp_eq_u32 s68, 0
s_cbranch_scc1 L_26
buffer_store_dwordx4 v[28:31], v241, s[4:7], s101 offen
L_27:
s_cmp_eq_u32 s68, 0
s_cbranch_scc1 L_28
buffer_store_dwordx2 v[28:29], v250, s[4:7], s84 offen
L_29:
v_and_b32 v52, 16, v1
v_cmp_eq_u32 vcc, 0, v52
v_lshlrev_b32 v52, 16, v48
v_and_b32 v53, 0xffff0000, v48
v_cndmask_b32 v248, v53, v52, vcc
v_lshlrev_b32 v52, 16, v50
v_and_b32 v53, 0xffff0000, v50
v_cndmask_b32 v249, v53, v52, vcc
v_lshlrev_b32 v52, 16, v58
v_and_b32 v53, 0xffff0000, v58
v_cndmask_b32 v243, v53, v52, vcc
v_add_f32 v243, 1.0, v243
v_cvt_pk_bf16_f32 v243, v243, v243
v_and_b32 v243, 0xffff0000, v243
v_mul_f32 v233, v249, v233
v_perm_b32 v52, v42, v40, s97
v_perm_b32 v53, v42, v40, s95
v_lshlrev_b32 v48, 16, v44
v_lshlrev_b32 v49, 16, v46
v_and_b32 v50, 0xffff0000, v44
v_and_b32 v51, 0xffff0000, v46
v_add_f32 v48, 1.0, v48
v_add_f32 v49, 1.0, v49
v_add_f32 v50, 1.0, v50
v_add_f32 v51, 1.0, v51
v_cvt_pk_bf16_f32 v48, v48, v49
v_cvt_pk_bf16_f32 v50, v50, v51
s_mov_b64 exec, s[28:29]
s_cbranch_execz L_30
ds_write_b32 v10, v48 offset:2304
ds_write_b32 v10, v50 offset:3456
ds_write_b32 v10, v52 offset:0
ds_write_b32 v10, v53 offset:1152
L_30:
s_mov_b64 exec, -1
s_mov_b32 s90, 0xaaaaaaaa
s_mov_b32 s91, 0xaaaaaaaa
s_mov_b32 s83, 0x3796feb5
v_mov_b64 v[244:245], 0
v_mov_b32 v246, v252
v_mov_b32 v247, 0
s_cmp_eq_u32 s62, 4
s_cselect_b64 vcc, -1, 0
v_mov_b64 v[36:37], 0
v_cndmask_b32 v38, 0, v234, vcc
v_mov_b32 v39, 0
s_and_b32 s16, s62, 3
s_lshl_b32 s16, s16, 7
v_add_u32 v252, s16, v8
s_waitcnt lgkmcnt(0)
s_waitcnt vmcnt(11)
s_barrier
s_mov_b32 s8, s44
s_mov_b32 s9, s45
s_mov_b32 s10, 5308416
s_mov_b32 s11, 0x20000
s_mul_i32 s18, s63, 288
s_mul_i32 s17, s62, 27648
s_add_u32 s18, s18, s17
s_mul_i32 s19, s62, 864
s_mov_b64 exec, s[26:27]
s_add_u32 m0, s19, 73728
s_add_u32 s17, s18, 3538944
buffer_load_dwordx4 v5, s[8:11], s17 offen  lds
s_add_u32 m0, s19, 80640
s_add_u32 s17, s18, 3760128
buffer_load_dwordx4 v5, s[8:11], s17 offen  lds
s_add_u32 m0, s19, 87552
s_add_u32 s17, s18, 3981312
buffer_load_dwordx4 v5, s[8:11], s17 offen  lds
s_add_u32 m0, s19, 94464
s_add_u32 s17, s18, 4202496
buffer_load_dwordx4 v5, s[8:11], s17 offen  lds
s_mov_b64 exec, -1
s_lshl_b32 s16, s62, 5
v_add_u32 v14, s16, v7
v_add_u32 v14, 110592, v14
v_add_u32 v15, 0x10000, v14
ds_read_b64_tr_b16 v[156:157], v14 offset:0
ds_read_b64_tr_b16 v[158:159], v14 offset:4608
ds_read_b64_tr_b16 v[160:161], v14 offset:9216
ds_read_b64_tr_b16 v[162:163], v14 offset:13824
ds_read_b64_tr_b16 v[164:165], v14 offset:18432
ds_read_b64_tr_b16 v[166:167], v14 offset:23040
s_cmp_lg_u32 s62, 5
s_cbranch_scc1 L_31
ds_read_b64_tr_b16 v[132:133], v14 offset:96
ds_read_b64_tr_b16 v[134:135], v14 offset:4704
L_31:
s_cmp_lg_u32 s62, 6
s_cbranch_scc1 L_32
ds_read_b64_tr_b16 v[128:129], v14 offset:9280
ds_read_b64_tr_b16 v[130:131], v14 offset:13888
ds_read_b64_tr_b16 v[132:133], v14 offset:18496
ds_read_b64_tr_b16 v[134:135], v14 offset:23104
L_32:
s_waitcnt lgkmcnt(0)
ds_read_b128 v[24:27], v240 offset:0
ds_read_b128 v[28:31], v240 offset:128
ds_read_b128 v[32:35], v240 offset:256
s_waitcnt lgkmcnt(2)
v_smfmac_f32_16x16x64_bf16 v[244:247], v[24:27], v[144:151], v13
s_cmp_lg_u32 s62, 4
s_cbranch_scc1 L_33
v_smfmac_f32_16x16x64_bf16 v[36:39], v[24:27], v[128:135], v13
L_33:
s_waitcnt lgkmcnt(1)
v_smfmac_f32_16x16x64_bf16 v[244:247], v[28:31], v[152:159], v13
s_cmp_lg_u32 s62, 5
s_cbranch_scc1 L_34
v_smfmac_f32_16x16x64_bf16 v[36:39], v[28:31], v[128:135], v13
L_34:
s_waitcnt lgkmcnt(0)
v_smfmac_f32_16x16x64_bf16 v[244:247], v[32:35], v[160:167], v13
s_cmp_lg_u32 s62, 6
s_cbranch_scc1 L_35
v_smfmac_f32_16x16x64_bf16 v[36:39], v[32:35], v[128:135], v13
L_35:
s_waitcnt vmcnt(11)
s_barrier
s_mov_b32 s8, s44
s_mov_b32 s9, s45
s_mov_b32 s10, 5308416
s_mov_b32 s11, 0x20000
s_mul_i32 s18, s63, 288
s_mul_i32 s17, s62, 27648
s_add_u32 s18, s18, s17
s_mul_i32 s19, s62, 864
s_mov_b64 exec, s[26:27]
s_add_u32 m0, s19, 110592
s_add_u32 s17, s18, 4423680
buffer_load_dwordx4 v5, s[8:11], s17 offen  lds
s_add_u32 m0, s19, 117504
s_add_u32 s17, s18, 4644864
buffer_load_dwordx4 v5, s[8:11], s17 offen  lds
s_add_u32 m0, s19, 124416
s_add_u32 s17, s18, 4866048
buffer_load_dwordx4 v5, s[8:11], s17 offen  lds
s_add_u32 m0, s19, 131328
s_add_u32 s17, s18, 5087232
buffer_load_dwordx4 v5, s[8:11], s17 offen  lds
s_mov_b64 exec, -1
s_lshl_b32 s16, s62, 5
v_add_u32 v14, s16, v7
v_add_u32 v15, 0x10000, v14
ds_read_b64_tr_b16 v[168:169], v14 offset:0
ds_read_b64_tr_b16 v[170:171], v14 offset:4608
ds_read_b64_tr_b16 v[172:173], v14 offset:9216
ds_read_b64_tr_b16 v[174:175], v14 offset:13824
ds_read_b64_tr_b16 v[176:177], v14 offset:18432
ds_read_b64_tr_b16 v[178:179], v14 offset:23040
s_cmp_lg_u32 s62, 4
s_cbranch_scc1 L_36
ds_read_b64_tr_b16 v[136:137], v14 offset:18560
ds_read_b64_tr_b16 v[138:139], v14 offset:23168
L_36:
s_cmp_lg_u32 s62, 7
s_cbranch_scc1 L_37
ds_read_b64_tr_b16 v[128:129], v14 offset:32
ds_read_b64_tr_b16 v[130:131], v14 offset:4640
ds_read_b64_tr_b16 v[132:133], v14 offset:9248
ds_read_b64_tr_b16 v[134:135], v14 offset:13856
L_37:
s_waitcnt lgkmcnt(0)
s_waitcnt vmcnt(11)
s_barrier
v_cmp_gt_u32 s[24:25], 7, v1
s_and_b32 s21, s62, 1
s_lshl_b32 s21, s21, 5
s_add_u32 s21, s21, s63
s_lshl_b32 s94, s21, 7
s_add_u32 s94, s94, 65536
v_mov_b32 v17, 2147483648
v_cndmask_b32 v16, v17, v237, s[24:25]
buffer_load_dwordx4 v[60:63], v241, s[4:7], s100 offen sc1
buffer_load_dwordx4 v[60:63], v241, s[4:7], s101 offen sc1
s_cmp_gt_u32 s63, 0
s_cbranch_scc1 L_38
buffer_load_dwordx4 v[60:63], v236, s[4:7], s84 offen sc1
L_38:
s_cmp_gt_u32 s62, 3
s_cbranch_scc1 L_39
s_mov_b32 s8, s48
s_mov_b32 s9, s49
s_mov_b32 s10, 5308416
s_mov_b32 s11, 0x20000
s_mul_i32 s18, s63, 165888
s_mul_i32 s17, s62, 9216
s_add_u32 s18, s18, s17
s_lshl_b32 s19, s62, 10
s_add_u32 m0, s19, 0
s_add_u32 s17, s18, 0
buffer_load_dwordx4 v4, s[8:11], s17 offen nt lds
s_add_u32 m0, s19, 4096
s_add_u32 s17, s18, 128
buffer_load_dwordx4 v4, s[8:11], s17 offen nt lds
s_add_u32 m0, s19, 8192
s_add_u32 s17, s18, 256
buffer_load_dwordx4 v4, s[8:11], s17 offen nt lds
s_add_u32 m0, s19, 12288
s_add_u32 s17, s18, 384
buffer_load_dwordx4 v4, s[8:11], s17 offen nt lds
s_add_u32 m0, s19, 16384
s_add_u32 s17, s18, 512
buffer_load_dwordx4 v4, s[8:11], s17 offen nt lds
s_add_u32 m0, s19, 20480
s_add_u32 s17, s18, 640
buffer_load_dwordx4 v4, s[8:11], s17 offen nt lds
s_add_u32 m0, s19, 24576
s_add_u32 s17, s18, 768
buffer_load_dwordx4 v4, s[8:11], s17 offen nt lds
s_add_u32 m0, s19, 28672
s_add_u32 s17, s18, 896
buffer_load_dwordx4 v4, s[8:11], s17 offen nt lds
s_add_u32 m0, s19, 32768
s_add_u32 s17, s18, 1024
buffer_load_dwordx4 v4, s[8:11], s17 offen nt lds
L_39:
s_lshl_b32 s16, s62, 5
v_add_u32 v14, s16, v7
v_add_u32 v14, 36864, v14
v_add_u32 v15, 0x10000, v14
ds_read_b64_tr_b16 v[180:181], v14 offset:0
ds_read_b64_tr_b16 v[182:183], v14 offset:4608
ds_read_b64_tr_b16 v[184:185], v14 offset:9216
ds_read_b64_tr_b16 v[186:187], v14 offset:13824
ds_read_b64_tr_b16 v[188:189], v14 offset:18432
ds_read_b64_tr_b16 v[190:191], v14 offset:23040
s_cmp_lg_u32 s62, 4
s_cbranch_scc1 L_40
ds_read_b64_tr_b16 v[140:141], v14 offset:128
ds_read_b64_tr_b16 v[142:143], v14 offset:4736
L_40:
s_cmp_lg_u32 s62, 5
s_cbranch_scc1 L_41
ds_read_b64_tr_b16 v[136:137], v14 offset:9312
ds_read_b64_tr_b16 v[138:139], v14 offset:13920
ds_read_b64_tr_b16 v[140:141], v14 offset:18528
ds_read_b64_tr_b16 v[142:143], v14 offset:23136
L_41:
s_waitcnt lgkmcnt(0)
ds_read_b128 v[24:27], v240 offset:384
ds_read_b128 v[28:31], v240 offset:512
ds_read_b128 v[32:35], v240 offset:640
s_waitcnt lgkmcnt(2)
v_smfmac_f32_16x16x64_bf16 v[244:247], v[24:27], v[168:175], v13
s_cmp_lg_u32 s62, 7
s_cbranch_scc1 L_42
v_smfmac_f32_16x16x64_bf16 v[36:39], v[24:27], v[128:135], v13
L_42:
s_waitcnt lgkmcnt(1)
v_smfmac_f32_16x16x64_bf16 v[244:247], v[28:31], v[176:183], v13
s_cmp_lg_u32 s62, 4
s_cbranch_scc1 L_43
v_smfmac_f32_16x16x64_bf16 v[36:39], v[28:31], v[136:143], v13
L_43:
s_waitcnt lgkmcnt(0)
v_smfmac_f32_16x16x64_bf16 v[244:247], v[32:35], v[184:191], v13
s_cmp_lg_u32 s62, 5
s_cbranch_scc1 L_44
v_smfmac_f32_16x16x64_bf16 v[36:39], v[32:35], v[136:143], v13
L_44:
s_cmp_gt_u32 s62, 3
s_cbranch_scc1 L_45
s_waitcnt vmcnt(15)
s_branch L_46
L_45:
s_waitcnt vmcnt(6)
L_46:
s_barrier
s_cmp_lg_u32 s62, 7
s_cbranch_scc1 L_47
v_mov_b32 v40, s66
v_cmp_eq_u32 vcc, 0, v1
v_mov_b32 v41, 2147483648
s_nop 0
v_cndmask_b32 v41, v41, 0, vcc
s_lshl_b32 s16, s63, 2
s_cmp_eq_u32 s68, 0
s_cbranch_scc1 L_48
buffer_store_dword v40, v41, s[4:7], s16 offen offset:512
L_49:
L_47:
s_cmp_gt_u32 s62, 3
s_cbranch_scc1 L_50
s_mov_b32 s8, s48
s_mov_b32 s9, s49
s_mov_b32 s10, 5308416
s_mov_b32 s11, 0x20000
s_mul_i32 s18, s63, 165888
s_mul_i32 s17, s62, 9216
s_add_u32 s18, s18, s17
s_lshl_b32 s19, s62, 10
s_add_u32 m0, s19, 36864
s_add_u32 s17, s18, 36864
buffer_load_dwordx4 v4, s[8:11], s17 offen nt lds
s_add_u32 m0, s19, 40960
s_add_u32 s17, s18, 36992
buffer_load_dwordx4 v4, s[8:11], s17 offen nt lds
s_add_u32 m0, s19, 45056
s_add_u32 s17, s18, 37120
buffer_load_dwordx4 v4, s[8:11], s17 offen nt lds
s_add_u32 m0, s19, 49152
s_add_u32 s17, s18, 37248
buffer_load_dwordx4 v4, s[8:11], s17 offen nt lds
s_add_u32 m0, s19, 53248
s_add_u32 s17, s18, 37376
buffer_load_dwordx4 v4, s[8:11], s17 offen nt lds
s_add_u32 m0, s19, 57344
s_add_u32 s17, s18, 37504
buffer_load_dwordx4 v4, s[8:11], s17 offen nt lds
s_add_u32 m0, s19, 61440
s_add_u32 s17, s18, 37632
buffer_load_dwordx4 v4, s[8:11], s17 offen nt lds
s_add_u32 m0, s19, 65536
s_add_u32 s17, s18, 37760
buffer_load_dwordx4 v4, s[8:11], s17 offen nt lds
s_add_u32 m0, s19, 69632
s_add_u32 s17, s18, 37888
buffer_load_dwordx4 v4, s[8:11], s17 offen nt lds
L_50:
s_lshl_b32 s16, s62, 5
v_add_u32 v14, s16, v7
v_add_u32 v14, 73728, v14
v_add_u32 v15, 0x10000, v14
ds_read_b64_tr_b16 v[192:193], v14 offset:0
ds_read_b64_tr_b16 v[194:195], v14 offset:4608
ds_read_b64_tr_b16 v[196:197], v14 offset:9216
ds_read_b64_tr_b16 v[198:199], v14 offset:13824
ds_read_b64_tr_b16 v[200:201], v14 offset:18432
ds_read_b64_tr_b16 v[202:203], v14 offset:23040
s_cmp_lg_u32 s62, 6
s_cbranch_scc1 L_51
ds_read_b64_tr_b16 v[136:137], v14 offset:64
ds_read_b64_tr_b16 v[138:139], v14 offset:4672
ds_read_b64_tr_b16 v[140:141], v14 offset:9280
ds_read_b64_tr_b16 v[142:143], v14 offset:13888
L_51:
s_cmp_lg_u32 s62, 7
s_cbranch_scc1 L_52
ds_read_b64_tr_b16 v[136:137], v14 offset:18464
ds_read_b64_tr_b16 v[138:139], v14 offset:23072
L_52:
s_waitcnt lgkmcnt(0)
s_cmp_gt_u32 s62, 3
s_cbranch_scc1 L_53
s_waitcnt vmcnt(20)
s_branch L_54
L_53:
s_waitcnt vmcnt(2)
L_54:
s_barrier
s_lshr_b32 s16, s62, 1
s_cmp_lg_u32 s16, 2
s_cbranch_scc1 L_55
buffer_load_dwordx4 v[20:23], v16, s[4:7], s94 offen sc1
L_55:
s_cmp_gt_u32 s62, 3
s_cbranch_scc1 L_56
s_mov_b32 s8, s48
s_mov_b32 s9, s49
s_mov_b32 s10, 5308416
s_mov_b32 s11, 0x20000
s_mul_i32 s18, s63, 165888
s_mul_i32 s17, s62, 9216
s_add_u32 s18, s18, s17
s_lshl_b32 s19, s62, 10
s_add_u32 m0, s19, 73728
s_add_u32 s17, s18, 73728
buffer_load_dwordx4 v4, s[8:11], s17 offen nt lds
s_add_u32 m0, s19, 77824
s_add_u32 s17, s18, 73856
buffer_load_dwordx4 v4, s[8:11], s17 offen nt lds
s_add_u32 m0, s19, 81920
s_add_u32 s17, s18, 73984
buffer_load_dwordx4 v4, s[8:11], s17 offen nt lds
s_add_u32 m0, s19, 86016
s_add_u32 s17, s18, 74112
buffer_load_dwordx4 v4, s[8:11], s17 offen nt lds
s_add_u32 m0, s19, 90112
s_add_u32 s17, s18, 74240
buffer_load_dwordx4 v4, s[8:11], s17 offen nt lds
s_add_u32 m0, s19, 94208
s_add_u32 s17, s18, 74368
buffer_load_dwordx4 v4, s[8:11], s17 offen nt lds
s_add_u32 m0, s19, 98304
s_add_u32 s17, s18, 74496
buffer_load_dwordx4 v4, s[8:11], s17 offen nt lds
s_add_u32 m0, s19, 102400
s_add_u32 s17, s18, 74624
buffer_load_dwordx4 v4, s[8:11], s17 offen nt lds
s_add_u32 m0, s19, 106496
s_add_u32 s17, s18, 74752
buffer_load_dwordx4 v4, s[8:11], s17 offen nt lds
L_56:
s_lshl_b32 s16, s62, 5
v_add_u32 v14, s16, v7
v_add_u32 v14, 110592, v14
v_add_u32 v15, 0x10000, v14
ds_read_b64_tr_b16 v[204:205], v14 offset:0
ds_read_b64_tr_b16 v[206:207], v14 offset:4608
ds_read_b64_tr_b16 v[208:209], v14 offset:9216
ds_read_b64_tr_b16 v[210:211], v14 offset:13824
ds_read_b64_tr_b16 v[212:213], v14 offset:18432
ds_read_b64_tr_b16 v[214:215], v14 offset:23040
s_cmp_lg_u32 s62, 4
s_cbranch_scc1 L_57
ds_read_b64_tr_b16 v[216:217], v14 offset:9344
ds_read_b64_tr_b16 v[218:219], v14 offset:13952
ds_read_b64_tr_b16 v[220:221], v14 offset:18560
ds_read_b64_tr_b16 v[222:223], v14 offset:23168
L_57:
s_cmp_lg_u32 s62, 7
s_cbranch_scc1 L_58
ds_read_b64_tr_b16 v[140:141], v14 offset:32
ds_read_b64_tr_b16 v[142:143], v14 offset:4640
L_58:
s_waitcnt lgkmcnt(0)
s_barrier
s_cmp_gt_u32 s62, 3
s_cbranch_scc1 L_59
s_mov_b32 s8, s48
s_mov_b32 s9, s49
s_mov_b32 s10, 5308416
s_mov_b32 s11, 0x20000
s_mul_i32 s18, s63, 165888
s_mul_i32 s17, s62, 9216
s_add_u32 s18, s18, s17
s_lshl_b32 s19, s62, 10
s_add_u32 m0, s19, 110592
s_add_u32 s17, s18, 110592
buffer_load_dwordx4 v4, s[8:11], s17 offen nt lds
s_add_u32 m0, s19, 114688
s_add_u32 s17, s18, 110720
buffer_load_dwordx4 v4, s[8:11], s17 offen nt lds
s_add_u32 m0, s19, 118784
s_add_u32 s17, s18, 110848
buffer_load_dwordx4 v4, s[8:11], s17 offen nt lds
s_add_u32 m0, s19, 122880
s_add_u32 s17, s18, 110976
buffer_load_dwordx4 v4, s[8:11], s17 offen nt lds
s_add_u32 m0, s19, 126976
s_add_u32 s17, s18, 111104
buffer_load_dwordx4 v4, s[8:11], s17 offen nt lds
s_add_u32 m0, s19, 131072
s_add_u32 s17, s18, 111232
buffer_load_dwordx4 v4, s[8:11], s17 offen nt lds
s_add_u32 m0, s19, 135168
s_add_u32 s17, s18, 111360
buffer_load_dwordx4 v4, s[8:11], s17 offen nt lds
s_add_u32 m0, s19, 139264
s_add_u32 s17, s18, 111488
buffer_load_dwordx4 v4, s[8:11], s17 offen nt lds
s_add_u32 m0, s19, 143360
s_add_u32 s17, s18, 111616
buffer_load_dwordx4 v4, s[8:11], s17 offen nt lds
L_59:
ds_read_b128 v[24:27], v240 offset:768
ds_read_b128 v[28:31], v240 offset:896
ds_read_b128 v[32:35], v240 offset:1024
s_waitcnt lgkmcnt(2)
v_smfmac_f32_16x16x64_bf16 v[244:247], v[24:27], v[192:199], v13
s_cmp_lg_u32 s62, 6
s_cbranch_scc1 L_60
v_smfmac_f32_16x16x64_bf16 v[36:39], v[24:27], v[136:143], v13
L_60:
s_waitcnt lgkmcnt(1)
v_smfmac_f32_16x16x64_bf16 v[244:247], v[28:31], v[200:207], v13
s_cmp_lg_u32 s62, 7
s_cbranch_scc1 L_61
v_smfmac_f32_16x16x64_bf16 v[36:39], v[28:31], v[136:143], v13
L_61:
s_waitcnt lgkmcnt(0)
v_smfmac_f32_16x16x64_bf16 v[244:247], v[32:35], v[208:215], v13
s_cmp_lg_u32 s62, 4
s_cbranch_scc1 L_62
v_smfmac_f32_16x16x64_bf16 v[36:39], v[32:35], v[216:223], v13
L_62:
s_cmp_gt_u32 s62, 3
s_cbranch_scc1 L_63
s_waitcnt vmcnt(18)
s_branch L_64
L_63:
s_waitcnt vmcnt(0)
L_64:
v_mov_b64 v[44:45], 0
v_mov_b64 v[46:47], 0
v_mov_b64 v[48:49], 0
v_mov_b64 v[50:51], 0
v_mov_b64 v[52:53], 0
v_mov_b64 v[54:55], 0
v_mov_b64 v[56:57], 0
v_mov_b64 v[58:59], 0
v_mov_b64 v[60:61], 0
v_mov_b64 v[62:63], 0
v_add_f32 v244, v244, v245
v_add_f32 v245, v246, v247
v_add_f32 v246, v36, v37
v_add_f32 v247, v38, v39
s_add_u32 s18, s31, 131072
s_add_u32 s19, s31, 262144
s_cmp_lg_u32 s62, 6
s_cbranch_scc1 L_66
v_and_b32 v16, 31, v1
v_lshlrev_b32 v16, 2, v16
s_mov_b32 s67, 0
buffer_load_dword v17, v16, s[4:7], 0 offen offset:512 sc1
CL_67:
s_waitcnt vmcnt(0)
v_bitop3_b32 v14, v17, v17, s66 bitop3:0x7e
v_cmp_ne_u32 vcc, 0, v14
s_cbranch_vccnz CLr_69
CLd_68:
L_66:
s_lshr_b32 s16, s62, 1
s_cmp_lg_u32 s16, 2
s_cbranch_scc1 MLskip_65
s_mov_b32 s16, s21
v_cmp_ne_u32 vcc, s66, v21
v_cmp_ne_u32 s[22:23], s66, v23
s_nop 0
s_or_b64 vcc, vcc, s[22:23]
s_and_b64 vcc, vcc, s[24:25]
s_cbranch_vccz L_mlok
s_mov_b32 s67, 0
buffer_load_dwordx4 v[20:23], v16, s[4:7], s94 offen sc1
ML_70:
s_waitcnt vmcnt(0)
v_bitop3_b32 v14, v21, v23, s66 bitop3:0x7e
v_cmp_ne_u32 vcc, 0, v14
s_nop 0
s_and_b64 vcc, vcc, s[24:25]
s_cbranch_vccnz MLr_72
MLd_71:
L_mlok:
v_mov_b32 v17, 0xff800000
v_cndmask_b32 v20, v17, v20, s[24:25]
v_mov_b32 v24, v20
s_nop 1
v_max_f32_dpp v24, v24, v24 quad_perm:[1,0,3,2] row_mask:0xf bank_mask:0xf
s_nop 1
v_max_f32_dpp v24, v24, v24 quad_perm:[2,3,0,1] row_mask:0xf bank_mask:0xf
s_nop 1
v_max_f32_dpp v24, v24, v24 row_half_mirror row_mask:0xf bank_mask:0xf
v_sub_f32 v20, v20, v24
v_mul_f32 v20, s30, v20
v_exp_f32 v20, v20
s_nop 0
v_mul_f32 v24, v20, v22
v_cndmask_b32 v24, 0, v24, s[24:25]
s_nop 1
v_add_f32_dpp v24, v24, v24 quad_perm:[1,0,3,2] row_mask:0xf bank_mask:0xf
s_nop 1
v_add_f32_dpp v24, v24, v24 quad_perm:[2,3,0,1] row_mask:0xf bank_mask:0xf
s_nop 1
v_add_f32_dpp v24, v24, v24 row_half_mirror row_mask:0xf bank_mask:0xf
v_rcp_f32 v24, v24
s_nop 0
v_mul_f32 v20, v20, v24
s_nop 0
v_readlane_b32 s76, v20, 0
v_readlane_b32 s77, v20, 1
v_readlane_b32 s78, v20, 2
v_readlane_b32 s79, v20, 3
v_readlane_b32 s80, v20, 4
v_readlane_b32 s81, v20, 5
v_readlane_b32 s82, v20, 6
s_lshl_b32 s16, s16, 13
s_add_u32 s16, s16, 786432
s_add_u32 s17, s16, 4096
s_mov_b32 s67, 0
buffer_load_dwordx4 v[16:19], v237, s[4:7], s16 offen offset:0 sc1
buffer_load_dwordx4 v[20:23], v237, s[4:7], s16 offen offset:1024 sc1
buffer_load_dwordx4 v[24:27], v237, s[4:7], s16 offen offset:2048 sc1
buffer_load_dwordx4 v[28:31], v237, s[4:7], s16 offen offset:3072 sc1
buffer_load_dwordx4 v[32:35], v237, s[4:7], s17 offen offset:0 sc1
buffer_load_dwordx4 v[36:39], v237, s[4:7], s17 offen offset:1024 sc1
buffer_load_dwordx4 v[40:43], v237, s[4:7], s17 offen offset:2048 sc1
L_e1:
s_waitcnt vmcnt(0)
v_bitop3_b32 v14, v17, v19, s66 bitop3:0x7e
v_bitop3_b32 v15, v21, v23, s66 bitop3:0x7e
v_bitop3_b32 v12, v25, v27, s66 bitop3:0x7e
v_or3_b32 v14, v14, v15, v12
v_bitop3_b32 v15, v29, v31, s66 bitop3:0x7e
v_bitop3_b32 v12, v33, v35, s66 bitop3:0x7e
v_or3_b32 v14, v14, v15, v12
v_bitop3_b32 v15, v37, v39, s66 bitop3:0x7e
v_bitop3_b32 v12, v41, v43, s66 bitop3:0x7e
v_or3_b32 v14, v14, v15, v12
v_cmp_ne_u32 vcc, 0, v14
s_cbranch_vccnz L_e1r
L_e1d:
v_mul_f32 v16, s76, v16
v_mul_f32 v18, s76, v18
v_fmac_f32 v16, s77, v20
v_fmac_f32 v18, s77, v22
v_fmac_f32 v16, s78, v24
v_fmac_f32 v18, s78, v26
v_fmac_f32 v16, s79, v28
v_fmac_f32 v18, s79, v30
v_fmac_f32 v16, s80, v32
v_fmac_f32 v18, s80, v34
v_fmac_f32 v16, s81, v36
v_fmac_f32 v18, s81, v38
v_fmac_f32 v16, s82, v40
v_fmac_f32 v18, s82, v42
v_cvt_pk_bf16_f32 v30, v16, v18
ds_write_b32 v2, v30 offset:4608
s_waitcnt lgkmcnt(0)
MLskip_65:
s_barrier
ds_read_b128 v[32:35], v9 offset:4608
ds_read_b128 v[36:39], v9 offset:4736
s_waitcnt lgkmcnt(1)
v_smfmac_f32_16x16x64_bf16 v[44:47], v[32:35], v[64:71], v13
s_waitcnt lgkmcnt(0)
v_smfmac_f32_16x16x64_bf16 v[44:47], v[36:39], v[72:79], v13
v_smfmac_f32_16x16x64_bf16 v[48:51], v[32:35], v[80:87], v13
v_smfmac_f32_16x16x64_bf16 v[48:51], v[36:39], v[88:95], v13
v_smfmac_f32_16x16x64_bf16 v[52:55], v[32:35], v[96:103], v13
v_smfmac_f32_16x16x64_bf16 v[52:55], v[36:39], v[104:111], v13
v_smfmac_f32_16x16x64_bf16 v[56:59], v[32:35], v[112:119], v13
v_smfmac_f32_16x16x64_bf16 v[56:59], v[36:39], v[120:127], v13
s_cmp_gt_u32 s62, 3
s_cbranch_scc1 Wy_81
v_smfmac_f32_16x16x64_bf16 v[60:63], v[32:35], v[128:135], v13
v_smfmac_f32_16x16x64_bf16 v[60:63], v[36:39], v[136:143], v13
Wy_81:
v_add_f32_dpp v40, v44, v45 quad_perm:[0,1,2,3] row_mask:0x1 bank_mask:0xf
v_add_f32_dpp v41, v46, v47 quad_perm:[0,1,2,3] row_mask:0x1 bank_mask:0xf
s_nop 0
v_add_f32_dpp v40, v48, v49 quad_perm:[0,1,2,3] row_mask:0x2 bank_mask:0xf
v_add_f32_dpp v41, v50, v51 quad_perm:[0,1,2,3] row_mask:0x2 bank_mask:0xf
s_nop 0
v_add_f32_dpp v40, v52, v53 quad_perm:[0,1,2,3] row_mask:0x4 bank_mask:0xf
v_add_f32_dpp v41, v54, v55 quad_perm:[0,1,2,3] row_mask:0x4 bank_mask:0xf
s_nop 0
v_add_f32_dpp v40, v56, v57 quad_perm:[0,1,2,3] row_mask:0x8 bank_mask:0xf
v_add_f32_dpp v41, v58, v59 quad_perm:[0,1,2,3] row_mask:0x8 bank_mask:0xf
s_cmp_eq_u32 s68, 0
s_cbranch_scc1 L_82
buffer_store_dwordx2 v[40:41], v11, s[4:7], s18 offen
L_83:
s_cmp_gt_u32 s62, 3
s_cbranch_scc1 Wx_80
v_add_f32 v42, v60, v61
v_add_f32 v43, v62, v63
s_mov_b64 exec, s[86:87]
s_cmp_eq_u32 s68, 0
s_cbranch_scc1 L_84
buffer_store_dwordx2 v[42:43], v11, s[4:7], s19 offen
L_85:
s_mov_b64 exec, -1
Wx_80:
s_cmp_gt_u32 s96, 17
s_cbranch_scc1 L_87
buffer_load_dwordx4 v[16:19], v237, s[4:7], s88 offen sc1
buffer_load_dwordx4 v[20:23], v237, s[4:7], s88 offen offset:1024 sc1
L_87:
s_lshr_b32 s16, s62, 2
s_lshl_b32 s16, s16, 12
v_add_u32 v14, s16, v6
v_add_u32 v15, 0x10000, v14
ds_read_b64_tr_b16 v[64:65], v14 offset:0
ds_read_b64_tr_b16 v[66:67], v14 offset:2048
ds_read_b64_tr_b16 v[80:81], v14 offset:8192
ds_read_b64_tr_b16 v[82:83], v14 offset:10240
ds_read_b64_tr_b16 v[96:97], v14 offset:16384
ds_read_b64_tr_b16 v[98:99], v14 offset:18432
ds_read_b64_tr_b16 v[112:113], v14 offset:24576
ds_read_b64_tr_b16 v[114:115], v14 offset:26624
s_cmp_gt_u32 s62, 3
s_cbranch_scc1 L_88
ds_read_b64_tr_b16 v[128:129], v14 offset:32768
ds_read_b64_tr_b16 v[130:131], v14 offset:34816
L_88:
s_waitcnt lgkmcnt(4)
s_cmp_gt_u32 s96, 17
s_cbranch_scc1 L_89
buffer_load_dwordx4 v[16:19], v237, s[4:7], s88 offen sc1
buffer_load_dwordx4 v[20:23], v237, s[4:7], s88 offen offset:1024 sc1
L_89:
s_lshr_b32 s16, s62, 2
s_lshl_b32 s16, s16, 12
v_add_u32 v14, s16, v6
v_add_u32 v14, 36864, v14
v_add_u32 v15, 0x10000, v14
ds_read_b64_tr_b16 v[68:69], v14 offset:0
ds_read_b64_tr_b16 v[70:71], v14 offset:2048
ds_read_b64_tr_b16 v[84:85], v14 offset:8192
ds_read_b64_tr_b16 v[86:87], v14 offset:10240
ds_read_b64_tr_b16 v[100:101], v14 offset:16384
ds_read_b64_tr_b16 v[102:103], v14 offset:18432
ds_read_b64_tr_b16 v[116:117], v14 offset:24576
ds_read_b64_tr_b16 v[118:119], v14 offset:26624
s_cmp_gt_u32 s62, 3
s_cbranch_scc1 L_90
ds_read_b64_tr_b16 v[132:133], v14 offset:32768
ds_read_b64_tr_b16 v[134:135], v14 offset:34816
L_90:
s_waitcnt lgkmcnt(4)
s_cmp_gt_u32 s96, 17
s_cbranch_scc1 L_91
s_mov_b32 s67, 0
s_mov_b32 s20, -2
s_branch E2Ac_93
E2A_92:
s_mov_b64 exec, vcc
buffer_load_dwordx4 v[16:19], v237, s[4:7], s88 offen sc1
buffer_load_dwordx4 v[20:23], v237, s[4:7], s88 offen offset:1024 sc1
s_mov_b64 exec, -1
s_add_u32 s67, s67, 1
s_cmp_ge_u32 s67, 262144
s_cselect_b32 s20, -1, -2
E2Ac_93:
s_waitcnt vmcnt(2)
v_max3_u32 v14, v16, v17, v18
v_max3_u32 v15, v19, v20, v21
v_max3_u32 v14, v14, v22, v23
v_max_u32 v14, v14, v15
v_cmp_lt_u32 vcc, s20, v14
s_cbranch_vccnz E2A_92
v_add_f32 v24, v16, v20
v_add_f32 v25, v17, v21
v_add_f32 v26, v18, v22
v_add_f32 v27, v19, v23
s_nop 0
v_permlane32_swap_b32 v24, v26
v_permlane32_swap_b32 v25, v27
v_add_f32 v24, v24, v26
v_add_f32 v25, v25, v27
s_nop 1
v_permlane16_swap_b32 v24, v25
v_add_f32 v24, v24, v25
s_nop 1
v_add_f32_dpp v24, v24, v24 row_ror:4 row_mask:0xf bank_mask:0xf
s_nop 1
v_add_f32_dpp v24, v24, v24 row_ror:8 row_mask:0xf bank_mask:0xf
v_fma_f32 v24, v248, v24, v232
v_mul_f32 v25, v24, v243
v_cvt_pk_bf16_f32 v26, v24, v25
v_mov_b32 v27, v26
v_add_f32 v12, v24, v233
s_nop 0
v_permlane16_swap_b32 v26, v27
s_cmp_eq_u32 s68, 0
s_cbranch_scc1 L_94
buffer_store_dwordx2 v[26:27], v250, s[4:7], s84 offen
L_95:
L_91:
s_add_u32 s18, s31, 458752
s_add_u32 s19, s31, 589824
v_mov_b64 v[36:37], 0
v_mov_b64 v[38:39], 0
v_mov_b64 v[40:41], 0
v_mov_b64 v[42:43], 0
v_mov_b64 v[44:45], 0
v_mov_b64 v[46:47], 0
v_mov_b64 v[48:49], 0
v_mov_b64 v[50:51], 0
v_mov_b64 v[52:53], 0
v_mov_b64 v[54:55], 0
v_mov_b64 v[56:57], 0
v_mov_b64 v[58:59], 0
v_mov_b64 v[60:61], 0
v_mov_b64 v[62:63], 0
s_waitcnt vmcnt(1)
s_barrier
s_cmp_gt_u32 s62, 4
s_cbranch_scc1 L_96
buffer_load_dwordx4 v[232:235], v236, s[4:7], s84 offen sc1
L_96:
s_lshr_b32 s16, s62, 2
s_lshl_b32 s16, s16, 12
v_add_u32 v14, s16, v6
v_add_u32 v14, 73728, v14
v_add_u32 v15, 0x10000, v14
ds_read_b64_tr_b16 v[72:73], v14 offset:0
ds_read_b64_tr_b16 v[74:75], v14 offset:2048
ds_read_b64_tr_b16 v[88:89], v14 offset:8192
ds_read_b64_tr_b16 v[90:91], v14 offset:10240
ds_read_b64_tr_b16 v[104:105], v14 offset:16384
ds_read_b64_tr_b16 v[106:107], v14 offset:18432
ds_read_b64_tr_b16 v[120:121], v14 offset:24576
ds_read_b64_tr_b16 v[122:123], v14 offset:26624
s_cmp_gt_u32 s62, 3
s_cbranch_scc1 L_97
ds_read_b64_tr_b16 v[136:137], v14 offset:32768
ds_read_b64_tr_b16 v[138:139], v14 offset:34816
L_97:
s_waitcnt lgkmcnt(4)
s_cmp_gt_u32 s62, 4
s_cbranch_scc1 L_98
buffer_load_dwordx4 v[232:235], v236, s[4:7], s84 offen sc1
L_98:
s_lshr_b32 s16, s62, 2
s_lshl_b32 s16, s16, 12
v_add_u32 v14, s16, v6
v_add_u32 v14, 110592, v14
v_add_u32 v15, 0x10000, v14
ds_read_b64_tr_b16 v[76:77], v14 offset:0
ds_read_b64_tr_b16 v[78:79], v14 offset:2048
ds_read_b64_tr_b16 v[92:93], v14 offset:8192
ds_read_b64_tr_b16 v[94:95], v14 offset:10240
ds_read_b64_tr_b16 v[108:109], v14 offset:16384
ds_read_b64_tr_b16 v[110:111], v14 offset:18432
ds_read_b64_tr_b16 v[124:125], v14 offset:24576
ds_read_b64_tr_b16 v[126:127], v14 offset:26624
s_cmp_gt_u32 s62, 3
s_cbranch_scc1 L_99
ds_read_b64_tr_b16 v[140:141], v14 offset:32768
ds_read_b64_tr_b16 v[142:143], v14 offset:34816
L_99:
s_waitcnt lgkmcnt(4)
s_cmp_gt_u32 s62, 4
s_cbranch_scc1 L2s_100
s_mov_b32 s67, 0
s_mov_b32 s20, -2
s_branch E2Bc_102
E2B_101:
s_mov_b64 exec, vcc
buffer_load_dwordx4 v[232:235], v236, s[4:7], s84 offen sc1
s_mov_b64 exec, -1
s_add_u32 s67, s67, 1
s_cmp_ge_u32 s67, 262144
s_cselect_b32 s20, -1, -2
E2Bc_102:
s_waitcnt vmcnt(1)
v_max3_u32 v14, v232, v233, v234
v_max_u32 v14, v14, v235
v_cmp_lt_u32 vcc, s20, v14
s_cbranch_vccnz E2B_101
v_perm_b32 v28, v234, v232, s95
v_perm_b32 v29, v235, v233, s95
ds_write_b32 v10, v28 offset:2304
ds_write_b32 v10, v29 offset:3456
v_perm_b32 v30, v234, v232, s97
v_perm_b32 v31, v235, v233, s97
v_dot2_f32_bf16 v24, v30, s85, 0
v_dot2_f32_bf16 v25, v31, s85, 0
v_dot2_f32_bf16 v26, v30, v30, s83
v_dot2_f32_bf16 v27, v31, v31, s83
s_nop 0
v_permlane32_swap_b32 v24, v25
s_nop 0
v_permlane32_swap_b32 v26, v27
v_add_f32 v24, v24, v25
v_add_f32 v26, v26, v27
s_nop 1
v_permlane16_swap_b32 v24, v26
v_add_f32 v24, v24, v26
s_nop 1
v_add_f32_dpp v24, v24, v24 quad_perm:[1,0,3,2] row_mask:0xf bank_mask:0xf
s_nop 1
v_add_f32_dpp v24, v24, v24 quad_perm:[2,3,0,1] row_mask:0xf bank_mask:0xf
s_nop 1
v_add_f32_dpp v24, v24, v24 row_half_mirror row_mask:0xf bank_mask:0xf
s_nop 1
v_add_f32_dpp v24, v24, v24 row_mirror row_mask:0xf bank_mask:0xf
ds_write_b32 v238, v24 offset:8704
L2s_100:
s_waitcnt lgkmcnt(0)
s_barrier
ds_read_b128 v[16:19], v8 offset:2304
ds_read_b128 v[20:23], v8 offset:2432
ds_read_b128 v[24:27], v8 offset:2560
ds_read_b128 v[28:31], v8 offset:2688
ds_read_b128 v[32:35], v8 offset:2816
ds_read_b128 v[240:243], v239 offset:8704
ds_read_b128 v[4:7], v239 offset:8720
ds_read_b64 v[14:15], v239 offset:8736
s_waitcnt lgkmcnt(7)
v_smfmac_f32_16x16x64_bf16 v[36:39], v[16:19], v[144:151], v13
ds_read_b128 v[16:19], v8 offset:2944
s_waitcnt lgkmcnt(7)
v_smfmac_f32_16x16x64_bf16 v[36:39], v[20:23], v[152:159], v13
ds_read_b128 v[20:23], v8 offset:3072
s_waitcnt lgkmcnt(7)
v_smfmac_f32_16x16x64_bf16 v[36:39], v[24:27], v[160:167], v13
ds_read_b128 v[24:27], v8 offset:3200
s_waitcnt lgkmcnt(7)
v_smfmac_f32_16x16x64_bf16 v[36:39], v[28:31], v[168:175], v13
ds_read_b128 v[28:31], v8 offset:3328
s_waitcnt lgkmcnt(7)
v_smfmac_f32_16x16x64_bf16 v[36:39], v[32:35], v[176:183], v13
ds_read_b128 v[32:35], v252 offset:2304
s_waitcnt lgkmcnt(5)
v_add_f32 v240, v240, v242
v_add_f32 v241, v241, v243
v_add_f32 v4, v4, v6
s_waitcnt lgkmcnt(4)
v_smfmac_f32_16x16x64_bf16 v[36:39], v[16:19], v[184:191], v13
ds_read_b128 v[16:19], v252 offset:2816
v_add_f32 v5, v5, v7
v_add_f32 v240, v240, v14
v_add_f32 v241, v241, v15
s_waitcnt lgkmcnt(4)
v_smfmac_f32_16x16x64_bf16 v[36:39], v[20:23], v[192:199], v13
v_add_f32 v240, v240, v4
v_add_f32 v241, v241, v5
v_mul_f32 v240, s98, v240
s_waitcnt lgkmcnt(3)
v_smfmac_f32_16x16x64_bf16 v[36:39], v[24:27], v[200:207], v13
v_mul_f32 v241, s98, v241
v_fma_f32 v241, -v240, v240, v241
v_rsq_f32 v241, v241
s_waitcnt lgkmcnt(2)
v_smfmac_f32_16x16x64_bf16 v[36:39], v[28:31], v[208:215], v13
v_mul_f32 v240, v240, v241
v_fma_f32 v245, -v240, v244, v245
v_fma_f32 v247, -v240, v246, v247
s_cmp_lt_u32 s62, 4
s_cbranch_scc1 W1w4_104
s_waitcnt lgkmcnt(0)
v_smfmac_f32_16x16x64_bf16 v[40:43], v[32:35], v[128:135], v13
v_smfmac_f32_16x16x64_bf16 v[40:43], v[16:19], v[136:143], v13
s_cmp_lg_u32 s62, 4
s_cbranch_scc1 W1w4_104
v_smfmac_f32_16x16x64_bf16 v[40:43], v[28:31], v[216:223], v13
W1w4_104:
s_nop 2
v_add_f32_dpp v36, v36, v37 quad_perm:[0,1,2,3] row_mask:0x1 bank_mask:0xf
s_nop 1
v_add_f32_dpp v36, v38, v39 quad_perm:[0,1,2,3] row_mask:0xe bank_mask:0xf
v_fma_f32 v36, v36, v241, v245
v_max_f32 v36, 0, v36
v_mul_f32 v36, v36, v36
v_cvt_pk_bf16_f32 v36, v36, v36
ds_write_b16 v3, v36 offset:5376
s_cmp_lt_u32 s62, 4
s_cbranch_scc1 W1l_103
v_add_f32_dpp v40, v40, v41 quad_perm:[0,1,2,3] row_mask:0x1 bank_mask:0xf
s_nop 1
v_add_f32_dpp v40, v42, v43 quad_perm:[0,1,2,3] row_mask:0xe bank_mask:0xf
v_fma_f32 v40, v40, v241, v247
ds_write_b32 v0, v40 offset:6112
W1l_103:
s_waitcnt lgkmcnt(0)
s_barrier
ds_read_b128 v[32:35], v9 offset:5376
ds_read_b128 v[36:39], v9 offset:5504
ds_read_b128 v[20:23], v253 offset:6144
ds_read_b128 v[24:27], v253 offset:6160
s_waitcnt lgkmcnt(3)
v_smfmac_f32_16x16x64_bf16 v[44:47], v[32:35], v[64:71], v13
s_waitcnt lgkmcnt(2)
v_smfmac_f32_16x16x64_bf16 v[44:47], v[36:39], v[72:79], v13
s_waitcnt lgkmcnt(0)
v_add_f32 v20, v20, v22
v_add_f32 v21, v21, v23
v_smfmac_f32_16x16x64_bf16 v[48:51], v[32:35], v[80:87], v13
v_add_f32 v24, v24, v26
v_add_f32 v25, v25, v27
v_smfmac_f32_16x16x64_bf16 v[48:51], v[36:39], v[88:95], v13
v_add_f32 v20, v20, v24
v_add_f32 v21, v21, v25
v_smfmac_f32_16x16x64_bf16 v[52:55], v[32:35], v[96:103], v13
v_max_f32 v20, 0, v20
v_max_f32 v21, 0, v21
v_smfmac_f32_16x16x64_bf16 v[52:55], v[36:39], v[104:111], v13
v_mul_f32 v20, v20, v20
v_mul_f32 v21, v21, v21
v_smfmac_f32_16x16x64_bf16 v[56:59], v[32:35], v[112:119], v13
v_cvt_pk_bf16_f32 v20, v20, v21
v_cndmask_b32 v28, v20, 0, s[90:91]
v_smfmac_f32_16x16x64_bf16 v[56:59], v[36:39], v[120:127], v13
v_cndmask_b32 v29, 0, v20, s[90:91]
s_nop 1
v_mfma_f32_16x16x16_bf16 v[44:47], v[28:29], v[224:225], v[44:47]
v_mfma_f32_16x16x16_bf16 v[48:51], v[28:29], v[226:227], v[48:51]
v_mfma_f32_16x16x16_bf16 v[52:55], v[28:29], v[228:229], v[52:55]
v_mfma_f32_16x16x16_bf16 v[56:59], v[28:29], v[230:231], v[56:59]
s_cmp_gt_u32 s62, 3
s_cbranch_scc1 Zy_106
v_smfmac_f32_16x16x64_bf16 v[60:63], v[32:35], v[128:135], v13
v_smfmac_f32_16x16x64_bf16 v[60:63], v[36:39], v[136:143], v13
Zy_106:
s_nop 2
v_add_f32_dpp v40, v44, v45 quad_perm:[0,1,2,3] row_mask:0x1 bank_mask:0xf
v_add_f32_dpp v41, v46, v47 quad_perm:[0,1,2,3] row_mask:0x1 bank_mask:0xf
s_nop 0
v_add_f32_dpp v40, v48, v49 quad_perm:[0,1,2,3] row_mask:0x2 bank_mask:0xf
v_add_f32_dpp v41, v50, v51 quad_perm:[0,1,2,3] row_mask:0x2 bank_mask:0xf
s_nop 0
v_add_f32_dpp v40, v52, v53 quad_perm:[0,1,2,3] row_mask:0x4 bank_mask:0xf
v_add_f32_dpp v41, v54, v55 quad_perm:[0,1,2,3] row_mask:0x4 bank_mask:0xf
s_nop 0
v_add_f32_dpp v40, v56, v57 quad_perm:[0,1,2,3] row_mask:0x8 bank_mask:0xf
v_add_f32_dpp v41, v58, v59 quad_perm:[0,1,2,3] row_mask:0x8 bank_mask:0xf
s_cmp_eq_u32 s68, 0
s_cbranch_scc1 L_107
buffer_store_dwordx2 v[40:41], v11, s[4:7], s18 offen
L_108:
s_cmp_gt_u32 s62, 3
s_cbranch_scc1 Zx_105
v_mfma_f32_16x16x16_bf16 v[60:63], v[28:29], v[222:223], v[60:63]
s_nop 7
v_add_f32 v42, v60, v61
v_add_f32 v43, v62, v63
s_mov_b64 exec, s[86:87]
s_cmp_eq_u32 s68, 0
s_cbranch_scc1 L_109
buffer_store_dwordx2 v[42:43], v11, s[4:7], s19 offen
L_110:
s_mov_b64 exec, -1
Zx_105:
s_cmp_gt_u32 s96, 17
s_cbranch_scc1 L_end
s_mov_b32 s67, 0
s_mov_b32 s20, -2
s_sleep 1
buffer_load_dwordx4 v[16:19], v237, s[4:7], s89 offen sc1
buffer_load_dwordx4 v[20:23], v237, s[4:7], s89 offen offset:1024 sc1
s_sleep 2
buffer_load_dwordx4 v[16:19], v237, s[4:7], s89 offen sc1
buffer_load_dwordx4 v[20:23], v237, s[4:7], s89 offen offset:1024 sc1
s_branch E3c_112
E3_111:
s_mov_b64 exec, vcc
buffer_load_dwordx4 v[16:19], v237, s[4:7], s89 offen sc1
buffer_load_dwordx4 v[20:23], v237, s[4:7], s89 offen offset:1024 sc1
s_mov_b64 exec, -1
s_add_u32 s67, s67, 1
s_cmp_ge_u32 s67, 262144
s_cselect_b32 s20, -1, -2
E3c_112:
s_waitcnt vmcnt(2)
v_max3_u32 v14, v16, v17, v18
v_max3_u32 v15, v19, v20, v21
v_max3_u32 v14, v14, v22, v23
v_max_u32 v14, v14, v15
v_cmp_lt_u32 vcc, s20, v14
s_cbranch_vccnz E3_111
v_add_f32 v24, v16, v20
v_add_f32 v25, v17, v21
v_add_f32 v26, v18, v22
v_add_f32 v27, v19, v23
s_nop 0
v_permlane32_swap_b32 v24, v26
v_permlane32_swap_b32 v25, v27
v_add_f32 v24, v24, v26
v_add_f32 v25, v25, v27
s_nop 1
v_permlane16_swap_b32 v24, v25
v_add_f32 v24, v24, v25
s_nop 1
v_add_f32_dpp v24, v24, v24 row_ror:4 row_mask:0xf bank_mask:0xf
s_nop 1
v_add_f32_dpp v24, v24, v24 row_ror:8 row_mask:0xf bank_mask:0xf
v_fma_f32 v24, v249, v24, v12
v_cvt_pk_bf16_f32 v24, v24, v24
buffer_store_short v24, v251, s[12:15], 0 offen
s_lshl_b32 s16, s63, 3
s_add_u32 s16, s16, s62
s_cmp_lg_u32 s16, 4
s_cbranch_scc1 L_end
v_mov_b32 v25, 2147483648
v_cmp_eq_u32 vcc, 0, v1
s_nop 1
v_cndmask_b32 v25, v25, 0, vcc
v_mov_b32 v26, s66
buffer_store_dword v26, v25, s[4:7], 0 offen offset:0 sc1
s_endpgm
L_24:
buffer_store_dwordx4 v[28:31], v241, s[4:7], s100 offen sc1
s_branch L_25
L_26:
buffer_store_dwordx4 v[28:31], v241, s[4:7], s101 offen sc1
s_branch L_27
L_28:
buffer_store_dwordx2 v[28:29], v250, s[4:7], s84 offen sc1
s_branch L_29
L_48:
buffer_store_dword v40, v41, s[4:7], s16 offen offset:512 sc1
s_branch L_49
CLr_69:
s_sleep 4
s_add_u32 s67, s67, 1
s_cmp_ge_u32 s67, 262144
s_cbranch_scc1 CLd_68
buffer_load_dword v17, v16, s[4:7], 0 offen offset:512 sc1
s_branch CL_67
MLr_72:
s_sleep 4
s_add_u32 s67, s67, 1
s_cmp_ge_u32 s67, 262144
s_cbranch_scc1 MLd_71
buffer_load_dwordx4 v[20:23], v16, s[4:7], s94 offen sc1
s_branch ML_70
L_e1r:
s_add_u32 s67, s67, 1
s_cmp_ge_u32 s67, 262144
s_cbranch_scc1 L_e1d
v_bitop3_b32 v14, v17, v19, s66 bitop3:0x7e
v_cmp_ne_u32 vcc, 0, v14
s_cbranch_vccz L_73
buffer_load_dwordx4 v[16:19], v237, s[4:7], s16 offen offset:0 sc1
L_73:
v_bitop3_b32 v14, v21, v23, s66 bitop3:0x7e
v_cmp_ne_u32 vcc, 0, v14
s_cbranch_vccz L_74
buffer_load_dwordx4 v[20:23], v237, s[4:7], s16 offen offset:1024 sc1
L_74:
v_bitop3_b32 v14, v25, v27, s66 bitop3:0x7e
v_cmp_ne_u32 vcc, 0, v14
s_cbranch_vccz L_75
buffer_load_dwordx4 v[24:27], v237, s[4:7], s16 offen offset:2048 sc1
L_75:
v_bitop3_b32 v14, v29, v31, s66 bitop3:0x7e
v_cmp_ne_u32 vcc, 0, v14
s_cbranch_vccz L_76
buffer_load_dwordx4 v[28:31], v237, s[4:7], s16 offen offset:3072 sc1
L_76:
v_bitop3_b32 v14, v33, v35, s66 bitop3:0x7e
v_cmp_ne_u32 vcc, 0, v14
s_cbranch_vccz L_77
buffer_load_dwordx4 v[32:35], v237, s[4:7], s17 offen offset:0 sc1
L_77:
v_bitop3_b32 v14, v37, v39, s66 bitop3:0x7e
v_cmp_ne_u32 vcc, 0, v14
s_cbranch_vccz L_78
buffer_load_dwordx4 v[36:39], v237, s[4:7], s17 offen offset:1024 sc1
L_78:
v_bitop3_b32 v14, v41, v43, s66 bitop3:0x7e
v_cmp_ne_u32 vcc, 0, v14
s_cbranch_vccz L_79
buffer_load_dwordx4 v[40:43], v237, s[4:7], s17 offen offset:2048 sc1
L_79:
s_branch L_e1
L_82:
buffer_store_dwordx2 v[40:41], v11, s[4:7], s18 offen sc1
s_branch L_83
L_84:
buffer_store_dwordx2 v[42:43], v11, s[4:7], s19 offen sc1
s_branch L_85
L_94:
buffer_store_dwordx2 v[26:27], v250, s[4:7], s84 offen sc1
s_branch L_95
L_107:
buffer_store_dwordx2 v[40:41], v11, s[4:7], s18 offen sc1
s_branch L_108
L_109:
buffer_store_dwordx2 v[42:43], v11, s[4:7], s19 offen sc1
s_branch L_110
L_end:
s_endpgm
L_code_end:
.section .rodata,"a"
.p2align 6
.amdhsa_kernel adaLN_cond__gqa_block_cached__dense_activation_squared_relu__decode_kernel
  .amdhsa_next_free_vgpr 256
  .amdhsa_next_free_sgpr 102
  .amdhsa_accum_offset 256
  .amdhsa_group_segment_fixed_size 0
  .amdhsa_kernarg_size 120
  .amdhsa_user_sgpr_count 2
  .amdhsa_user_sgpr_kernarg_segment_ptr 1
  .amdhsa_system_sgpr_workgroup_id_x 1
.end_amdhsa_kernel
```
